```python
import torch

def _softmax(x, axis=-1):
    return torch.softmax(x, dim=axis)
def _gelu(x):
    return torch.nn.functional.gelu(x, approximate="tanh")
def _silu(x):
    return torch.nn.functional.silu(x)
def _sigmoid(x):
    return torch.sigmoid(x)
def _layernorm(x, axis=-1, eps=1e-5):
    m = x.mean(dim=axis, keepdim=True)
    v = x.var(dim=axis, keepdim=True, unbiased=False)
    return (x - m) / torch.sqrt(v + eps)
def _scatter_add(tgt, idx, src, axis=0):
    return tgt.clone().index_add_(axis, idx, src)
def _segment_sum(src, seg, n):
    out = torch.zeros((n,) + src.shape[1:], dtype=src.dtype)
    return out.index_add_(0, seg, src)
def _pad(x, pw):
    flat = tuple(v for pair in reversed(pw) for v in pair)
    return torch.nn.functional.pad(x, flat)

kernel_name = 'sequential_preLN__spectral_fnet__moe_arch_mod__prompt'

def setup_inputs():

    _w = (lambda a: (lambda t: t.to(torch.bfloat16) if t.is_floating_point() else t)(torch.as_tensor(a)))
    def _A_setup():
        B, S, D = 1, 2048, 512
        ns = torch.arange(S)[:, None] * torch.arange(S)[None, :]
        nd = torch.arange(D)[:, None] * torch.arange(D)[None, :]
        Ws_re = torch.cos(-2.0 * torch.pi * ns / S).to(float)
        Ws_im = torch.sin(-2.0 * torch.pi * ns / S).to(float)
        Wd_re = torch.cos(-2.0 * torch.pi * nd / D).to(float)
        Wd_im = torch.sin(-2.0 * torch.pi * nd / D).to(float)
        return {
            "x": _w((lambda *s: torch.randn(*s, dtype=torch.bfloat16) * 0.1)(B, S, D)),
            "dft_seq_re": _w(Ws_re),
            "dft_seq_im": _w(Ws_im),
            "dft_hid_re": _w(Wd_re),
            "dft_hid_im": _w(Wd_im),
        }
    _A_in = _A_setup()

    def _B_setup():
        B, S, D, F, C = 1, 2048, 512, 1792, 8
        return {
            "x": _w((lambda *s: torch.randn(*s, dtype=torch.bfloat16) * 0.1)(B, S, D)),
            "w_r": _w((lambda *s: torch.randn(*s, dtype=torch.bfloat16) * 1.6)(D)),
            "w_gate": _w((lambda *s: torch.randn(*s, dtype=torch.bfloat16) * 0.8)(D, F)),
            "w_up": _w((lambda *s: torch.randn(*s, dtype=torch.bfloat16) * 0.8)(D, F)),
            "w_down": _w((lambda *s: torch.randn(*s, dtype=torch.bfloat16) * 0.8)(F, D)),
        }
    _B_in = _B_setup()

    return {
        "A_x": _A_in["x"],
        "A_dft_seq_re": _A_in["dft_seq_re"],
        "A_dft_seq_im": _A_in["dft_seq_im"],
        "A_dft_hid_re": _A_in["dft_hid_re"],
        "A_dft_hid_im": _A_in["dft_hid_im"],
        "B_x": _B_in["x"],
        "B_w_r": _B_in["w_r"],
        "B_w_gate": _B_in["w_gate"],
        "B_w_up": _B_in["w_up"],
        "B_w_down": _B_in["w_down"],
    }

def reference(A_x, A_dft_seq_re, A_dft_seq_im, A_dft_hid_re, A_dft_hid_im, B_x, B_w_r, B_w_gate, B_w_up, B_w_down):
    def _A_ref(x, dft_seq_re, dft_seq_im, dft_hid_re, dft_hid_im):
        a = torch.einsum("bsd,ed->bse", x, dft_hid_re)
        b = torch.einsum("bsd,ed->bse", x, dft_hid_im)
        y = torch.einsum("ts,bse->bte", dft_seq_re, a) - torch.einsum("ts,bse->bte", dft_seq_im, b)
        return y

    def _B_ref(x, w_r, w_gate, w_up, w_down):
        B, S, D = x.shape
        C = 8
        r = x @ w_r
        idx = torch.argsort(-r, axis=-1)[:, :C]
        idx_e = (lambda x, n, axis: torch.repeat_interleave(x, n, dim=axis))(idx.reshape(B, C, 1), D, axis=2)
        x_sel = (lambda x, i, axis: torch.take_along_dim(x, i, dim=axis))(x, idx_e, axis=1)
        g = _silu(x_sel @ w_gate)
        u = x_sel @ w_up
        y = (g * u) @ w_down
        r_sel = _sigmoid((lambda x, i, axis: torch.take_along_dim(x, i, dim=axis))(r, idx, axis=1))
        y = y * r_sel.reshape(B, C, 1)
        b_off = (torch.arange(B) * S).reshape(B, 1)
        flat_idx = (idx + b_off).reshape(B * C)
        zero = (x * 0.0).reshape(B * S, D)
        upd = _scatter_add(zero, flat_idx, y.reshape(B * C, D), axis=0)
        return x + upd.reshape(B, S, D)

    x = A_x
    h = x + _A_ref(_layernorm(x, axis=-1), A_dft_seq_re, A_dft_seq_im, A_dft_hid_re, A_dft_hid_im)
    h2 = h + _B_ref(_layernorm(h, axis=-1), B_w_r, B_w_gate, B_w_up, B_w_down)
    return h2
```

```asm
; @launch kernel=f_kernel grid=(256,1,1) block=(576,1,1) lds=147712
; @launch kernel=t4_kernel grid=(240,1,1) block=(256,1,1) lds=123392
.amdgcn_target "amdgcn-amd-amdhsa--gfx950"
.text
.globl f_kernel
.p2align 8
.type f_kernel,@function
f_kernel:
  s_cmp_ge_u32 s2, 256
  s_cbranch_scc1 k2_done
  s_load_dwordx2 s[4:5], s[0:1], 0
  s_load_dwordx4 s[8:11], s[0:1], 24
  s_load_dwordx2 s[6:7], s[0:1], 96
  s_load_dwordx4 s[52:55], s[0:1], 8
  s_load_dwordx2 s[66:67], s[0:1], 88
  s_load_dwordx2 s[34:35], s[0:1], 72
  s_and_b32 s12, s2, 7
  s_lshr_b32 s13, s2, 3
  s_and_b32 s14, s13, 3
  s_lshl_b32 s12, s12, 2
  s_add_u32 s12, s12, s14
  s_lshr_b32 s13, s13, 2
  v_lshrrev_b32 v1, 6, v0
  v_and_b32 v0, 63, v0
  v_readfirstlane_b32 s15, v1
  v_lshrrev_b32 v2, 3, v0
  v_and_b32 v3, 7, v0
  s_waitcnt lgkmcnt(0)
  s_mov_b32 s96, s66
  s_mov_b32 s97, s67
  s_mov_b32 s98, 256
  s_mov_b32 s99, 0x00020000
  s_cmp_lg_u32 s15, 8
  s_cbranch_scc1 f_main
  s_cmp_lg_u32 s2, 0
  s_cbranch_scc1 f_noepoch
  s_memrealtime s[40:41]
  s_waitcnt lgkmcnt(0)
  s_or_b32 s40, s40, 1
  v_mov_b32 v4, s40
  v_mov_b32 v5, 0
  s_mov_b64 s[42:43], exec
  s_mov_b64 exec, 1
  buffer_store_dword v4, v5, s[96:99], 0 offen sc1
  s_mov_b64 exec, s[42:43]
f_noepoch:
  s_mov_b32 s36, s34
  s_mov_b32 s37, s35
  s_mov_b32 s38, 1835008
  s_mov_b32 s39, 0x00020000
  s_mov_b32 s40, s6
  s_mov_b32 s41, s7
  s_mov_b32 s42, 12582912
  s_mov_b32 s43, 0x00020000
  v_lshlrev_b32 v2, 4, v0
  s_mul_i32 s44, s2, 7168
  buffer_load_dwordx4 v[8:11], v2, s[36:39], s44 offen
  s_add_u32 s44, s44, 1024
  buffer_load_dwordx4 v[12:15], v2, s[36:39], s44 offen
  s_add_u32 s44, s44, 1024
  buffer_load_dwordx4 v[16:19], v2, s[36:39], s44 offen
  s_add_u32 s44, s44, 1024
  buffer_load_dwordx4 v[20:23], v2, s[36:39], s44 offen
  s_add_u32 s44, s44, 1024
  buffer_load_dwordx4 v[24:27], v2, s[36:39], s44 offen
  s_add_u32 s44, s44, 1024
  buffer_load_dwordx4 v[28:31], v2, s[36:39], s44 offen
  s_add_u32 s44, s44, 1024
  buffer_load_dwordx4 v[32:35], v2, s[36:39], s44 offen
  s_add_u32 s44, s44, 1024
  s_cmp_ge_u32 s2, 28
  s_cbranch_scc1 k2_nomark
  v_mov_b32 v4, -1
  v_mov_b32 v5, -1
  v_mov_b32 v6, -1
  v_mov_b32 v7, -1
  s_lshl_b32 s44, s2, 10
  s_add_u32 s44, s44, 8454144
  buffer_store_dwordx4 v[4:7], v2, s[40:43], s44 offen
k2_nomark:
  v_mul_u32_u24 v3, 28672, v0
  s_mul_i32 s44, s2, 112
  s_add_u32 s44, s44, 10485760
  s_waitcnt vmcnt(0)
  buffer_store_dwordx4 v[8:11], v3, s[40:43], s44 offen offset:0
  buffer_store_dwordx4 v[12:15], v3, s[40:43], s44 offen offset:16
  buffer_store_dwordx4 v[16:19], v3, s[40:43], s44 offen offset:32
  buffer_store_dwordx4 v[20:23], v3, s[40:43], s44 offen offset:48
  buffer_store_dwordx4 v[24:27], v3, s[40:43], s44 offen offset:64
  buffer_store_dwordx4 v[28:31], v3, s[40:43], s44 offen offset:80
  buffer_store_dwordx4 v[32:35], v3, s[40:43], s44 offen offset:96
  s_branch k2_done
f_main:
  s_mov_b32 s16, s4
  s_mov_b32 s17, s5
  s_mov_b32 s18, 2097152
  s_mov_b32 s19, 0x00020000
  s_cmp_lt_u32 s13, 4
  s_cselect_b32 s20, s8, s10
  s_cselect_b32 s21, s9, s11
  s_mov_b32 s22, 524288
  s_mov_b32 s23, 0x00020000
  s_mov_b32 s24, s6
  s_mov_b32 s25, s7
  s_mov_b32 s26, 9437184
  s_mov_b32 s27, 0x00020000
  s_lshl_b32 s28, s12, 6
  s_lshl_b32 s29, s15, 3
  s_add_u32 s28, s28, s29
  v_add_u32 v4, s28, v2
  v_lshlrev_b32 v4, 10, v4
  v_lshl_add_u32 v4, v3, 4, v4
  buffer_load_dwordx4 v[32:35], v4, s[16:19], 0 offen offset:0
  buffer_load_dwordx4 v[36:39], v4, s[16:19], 0 offen offset:128
  buffer_load_dwordx4 v[40:43], v4, s[16:19], 0 offen offset:256
  buffer_load_dwordx4 v[44:47], v4, s[16:19], 0 offen offset:384
  buffer_load_dwordx4 v[48:51], v4, s[16:19], 0 offen offset:512
  buffer_load_dwordx4 v[52:55], v4, s[16:19], 0 offen offset:640
  buffer_load_dwordx4 v[56:59], v4, s[16:19], 0 offen offset:768
  buffer_load_dwordx4 v[60:63], v4, s[16:19], 0 offen offset:896
  s_and_b32 s30, s13, 3
  s_lshl_b32 s30, s30, 7
  s_lshl_b32 s31, s15, 4
  s_add_u32 s31, s31, 0
  v_add_u32 v7, s31, v2
  v_lshrrev_b32 v8, 1, v7
  v_and_b32 v8, 7, v8
  v_xor_b32 v8, v8, v3
  v_add_u32 v7, s30, v7
  v_lshlrev_b32 v7, 10, v7
  v_lshl_add_u32 v5, v8, 4, v7
  s_lshl_b32 s31, s15, 4
  s_add_u32 s31, s31, 8
  v_add_u32 v7, s31, v2
  v_lshrrev_b32 v8, 1, v7
  v_and_b32 v8, 7, v8
  v_xor_b32 v8, v8, v3
  v_add_u32 v7, s30, v7
  v_lshlrev_b32 v7, 10, v7
  v_lshl_add_u32 v6, v8, 4, v7
  s_lshl_b32 s32, s15, 11
  s_mov_b32 s33, 0
  s_add_u32 m0, s32, 0
  s_nop 0
  buffer_load_dwordx4 v5, s[20:23], s33 offen lds
  s_add_u32 m0, s32, 1024
  s_nop 0
  buffer_load_dwordx4 v6, s[20:23], s33 offen lds
  s_mov_b32 s33, 128
  s_add_u32 m0, s32, 16384
  s_nop 0
  buffer_load_dwordx4 v5, s[20:23], s33 offen lds
  s_add_u32 m0, s32, 17408
  s_nop 0
  buffer_load_dwordx4 v6, s[20:23], s33 offen lds
  s_mov_b32 s33, 256
  s_add_u32 m0, s32, 32768
  s_nop 0
  buffer_load_dwordx4 v5, s[20:23], s33 offen lds
  s_add_u32 m0, s32, 33792
  s_nop 0
  buffer_load_dwordx4 v6, s[20:23], s33 offen lds
  s_mov_b32 s33, 384
  s_add_u32 m0, s32, 49152
  s_nop 0
  buffer_load_dwordx4 v5, s[20:23], s33 offen lds
  s_add_u32 m0, s32, 50176
  s_nop 0
  buffer_load_dwordx4 v6, s[20:23], s33 offen lds
  s_mov_b32 s34, 0x3f803f80
  v_mov_b32 v8, 0
  v_mov_b32 v9, 0
  v_mov_b32 v10, 0
  v_mov_b32 v11, 0
  s_waitcnt vmcnt(8)
  v_dot2_f32_bf16 v8, v32, s34, v8
  v_dot2_f32_bf16 v9, v33, s34, v9
  v_dot2_f32_bf16 v10, v34, s34, v10
  v_dot2_f32_bf16 v11, v35, s34, v11
  v_dot2_f32_bf16 v8, v36, s34, v8
  v_dot2_f32_bf16 v9, v37, s34, v9
  v_dot2_f32_bf16 v10, v38, s34, v10
  v_dot2_f32_bf16 v11, v39, s34, v11
  v_dot2_f32_bf16 v8, v40, s34, v8
  v_dot2_f32_bf16 v9, v41, s34, v9
  v_dot2_f32_bf16 v10, v42, s34, v10
  v_dot2_f32_bf16 v11, v43, s34, v11
  v_dot2_f32_bf16 v8, v44, s34, v8
  v_dot2_f32_bf16 v9, v45, s34, v9
  v_dot2_f32_bf16 v10, v46, s34, v10
  v_dot2_f32_bf16 v11, v47, s34, v11
  v_dot2_f32_bf16 v8, v48, s34, v8
  v_dot2_f32_bf16 v9, v49, s34, v9
  v_dot2_f32_bf16 v10, v50, s34, v10
  v_dot2_f32_bf16 v11, v51, s34, v11
  v_dot2_f32_bf16 v8, v52, s34, v8
  v_dot2_f32_bf16 v9, v53, s34, v9
  v_dot2_f32_bf16 v10, v54, s34, v10
  v_dot2_f32_bf16 v11, v55, s34, v11
  v_dot2_f32_bf16 v8, v56, s34, v8
  v_dot2_f32_bf16 v9, v57, s34, v9
  v_dot2_f32_bf16 v10, v58, s34, v10
  v_dot2_f32_bf16 v11, v59, s34, v11
  v_dot2_f32_bf16 v8, v60, s34, v8
  v_dot2_f32_bf16 v9, v61, s34, v9
  v_dot2_f32_bf16 v10, v62, s34, v10
  v_dot2_f32_bf16 v11, v63, s34, v11
  s_nop 3
  v_add_f32 v8, v8, v9
  v_add_f32 v10, v10, v11
  v_add_f32 v8, v8, v10
  s_nop 1
  v_add_f32_dpp v8, v8, v8 quad_perm:[1,0,3,2] row_mask:0xf bank_mask:0xf
  s_nop 1
  v_add_f32_dpp v8, v8, v8 quad_perm:[2,3,0,1] row_mask:0xf bank_mask:0xf
  s_nop 1
  v_add_f32_dpp v8, v8, v8 row_half_mirror row_mask:0xf bank_mask:0xf
  v_mul_f32 v8, 0x3b000000, v8
  v_cvt_pk_bf16_f32 v9, v8, v8
  v_lshlrev_b32 v9, 16, v9
  v_sub_f32 v10, 0, v9
  v_mov_b32 v11, v10
  v_mov_b32 v12, 0
  v_mov_b32 v13, 0
  v_mov_b32 v14, 0
  v_mov_b32 v15, 0
  v_lshlrev_b32 v64, 16, v32
  v_and_b32 v65, 0xffff0000, v32
  v_pk_add_f32 v[64:65], v[64:65], v[10:11]
  v_pk_fma_f32 v[12:13], v[64:65], v[64:65], v[12:13]
  v_lshlrev_b32 v66, 16, v33
  v_and_b32 v67, 0xffff0000, v33
  v_pk_add_f32 v[66:67], v[66:67], v[10:11]
  v_pk_fma_f32 v[14:15], v[66:67], v[66:67], v[14:15]
  v_lshlrev_b32 v68, 16, v34
  v_and_b32 v69, 0xffff0000, v34
  v_pk_add_f32 v[68:69], v[68:69], v[10:11]
  v_pk_fma_f32 v[12:13], v[68:69], v[68:69], v[12:13]
  v_lshlrev_b32 v70, 16, v35
  v_and_b32 v71, 0xffff0000, v35
  v_pk_add_f32 v[70:71], v[70:71], v[10:11]
  v_pk_fma_f32 v[14:15], v[70:71], v[70:71], v[14:15]
  v_lshlrev_b32 v72, 16, v36
  v_and_b32 v73, 0xffff0000, v36
  v_pk_add_f32 v[72:73], v[72:73], v[10:11]
  v_pk_fma_f32 v[12:13], v[72:73], v[72:73], v[12:13]
  v_lshlrev_b32 v74, 16, v37
  v_and_b32 v75, 0xffff0000, v37
  v_pk_add_f32 v[74:75], v[74:75], v[10:11]
  v_pk_fma_f32 v[14:15], v[74:75], v[74:75], v[14:15]
  v_lshlrev_b32 v76, 16, v38
  v_and_b32 v77, 0xffff0000, v38
  v_pk_add_f32 v[76:77], v[76:77], v[10:11]
  v_pk_fma_f32 v[12:13], v[76:77], v[76:77], v[12:13]
  v_lshlrev_b32 v78, 16, v39
  v_and_b32 v79, 0xffff0000, v39
  v_pk_add_f32 v[78:79], v[78:79], v[10:11]
  v_pk_fma_f32 v[14:15], v[78:79], v[78:79], v[14:15]
  v_lshlrev_b32 v80, 16, v40
  v_and_b32 v81, 0xffff0000, v40
  v_pk_add_f32 v[80:81], v[80:81], v[10:11]
  v_pk_fma_f32 v[12:13], v[80:81], v[80:81], v[12:13]
  v_lshlrev_b32 v82, 16, v41
  v_and_b32 v83, 0xffff0000, v41
  v_pk_add_f32 v[82:83], v[82:83], v[10:11]
  v_pk_fma_f32 v[14:15], v[82:83], v[82:83], v[14:15]
  v_lshlrev_b32 v84, 16, v42
  v_and_b32 v85, 0xffff0000, v42
  v_pk_add_f32 v[84:85], v[84:85], v[10:11]
  v_pk_fma_f32 v[12:13], v[84:85], v[84:85], v[12:13]
  v_lshlrev_b32 v86, 16, v43
  v_and_b32 v87, 0xffff0000, v43
  v_pk_add_f32 v[86:87], v[86:87], v[10:11]
  v_pk_fma_f32 v[14:15], v[86:87], v[86:87], v[14:15]
  v_lshlrev_b32 v88, 16, v44
  v_and_b32 v89, 0xffff0000, v44
  v_pk_add_f32 v[88:89], v[88:89], v[10:11]
  v_pk_fma_f32 v[12:13], v[88:89], v[88:89], v[12:13]
  v_lshlrev_b32 v90, 16, v45
  v_and_b32 v91, 0xffff0000, v45
  v_pk_add_f32 v[90:91], v[90:91], v[10:11]
  v_pk_fma_f32 v[14:15], v[90:91], v[90:91], v[14:15]
  v_lshlrev_b32 v92, 16, v46
  v_and_b32 v93, 0xffff0000, v46
  v_pk_add_f32 v[92:93], v[92:93], v[10:11]
  v_pk_fma_f32 v[12:13], v[92:93], v[92:93], v[12:13]
  v_lshlrev_b32 v94, 16, v47
  v_and_b32 v95, 0xffff0000, v47
  v_pk_add_f32 v[94:95], v[94:95], v[10:11]
  v_pk_fma_f32 v[14:15], v[94:95], v[94:95], v[14:15]
  v_lshlrev_b32 v96, 16, v48
  v_and_b32 v97, 0xffff0000, v48
  v_pk_add_f32 v[96:97], v[96:97], v[10:11]
  v_pk_fma_f32 v[12:13], v[96:97], v[96:97], v[12:13]
  v_lshlrev_b32 v98, 16, v49
  v_and_b32 v99, 0xffff0000, v49
  v_pk_add_f32 v[98:99], v[98:99], v[10:11]
  v_pk_fma_f32 v[14:15], v[98:99], v[98:99], v[14:15]
  v_lshlrev_b32 v100, 16, v50
  v_and_b32 v101, 0xffff0000, v50
  v_pk_add_f32 v[100:101], v[100:101], v[10:11]
  v_pk_fma_f32 v[12:13], v[100:101], v[100:101], v[12:13]
  v_lshlrev_b32 v102, 16, v51
  v_and_b32 v103, 0xffff0000, v51
  v_pk_add_f32 v[102:103], v[102:103], v[10:11]
  v_pk_fma_f32 v[14:15], v[102:103], v[102:103], v[14:15]
  v_lshlrev_b32 v104, 16, v52
  v_and_b32 v105, 0xffff0000, v52
  v_pk_add_f32 v[104:105], v[104:105], v[10:11]
  v_pk_fma_f32 v[12:13], v[104:105], v[104:105], v[12:13]
  v_lshlrev_b32 v106, 16, v53
  v_and_b32 v107, 0xffff0000, v53
  v_pk_add_f32 v[106:107], v[106:107], v[10:11]
  v_pk_fma_f32 v[14:15], v[106:107], v[106:107], v[14:15]
  v_lshlrev_b32 v108, 16, v54
  v_and_b32 v109, 0xffff0000, v54
  v_pk_add_f32 v[108:109], v[108:109], v[10:11]
  v_pk_fma_f32 v[12:13], v[108:109], v[108:109], v[12:13]
  v_lshlrev_b32 v110, 16, v55
  v_and_b32 v111, 0xffff0000, v55
  v_pk_add_f32 v[110:111], v[110:111], v[10:11]
  v_pk_fma_f32 v[14:15], v[110:111], v[110:111], v[14:15]
  v_lshlrev_b32 v112, 16, v56
  v_and_b32 v113, 0xffff0000, v56
  v_pk_add_f32 v[112:113], v[112:113], v[10:11]
  v_pk_fma_f32 v[12:13], v[112:113], v[112:113], v[12:13]
  v_lshlrev_b32 v114, 16, v57
  v_and_b32 v115, 0xffff0000, v57
  v_pk_add_f32 v[114:115], v[114:115], v[10:11]
  v_pk_fma_f32 v[14:15], v[114:115], v[114:115], v[14:15]
  v_lshlrev_b32 v116, 16, v58
  v_and_b32 v117, 0xffff0000, v58
  v_pk_add_f32 v[116:117], v[116:117], v[10:11]
  v_pk_fma_f32 v[12:13], v[116:117], v[116:117], v[12:13]
  v_lshlrev_b32 v118, 16, v59
  v_and_b32 v119, 0xffff0000, v59
  v_pk_add_f32 v[118:119], v[118:119], v[10:11]
  v_pk_fma_f32 v[14:15], v[118:119], v[118:119], v[14:15]
  v_lshlrev_b32 v120, 16, v60
  v_and_b32 v121, 0xffff0000, v60
  v_pk_add_f32 v[120:121], v[120:121], v[10:11]
  v_pk_fma_f32 v[12:13], v[120:121], v[120:121], v[12:13]
  v_lshlrev_b32 v122, 16, v61
  v_and_b32 v123, 0xffff0000, v61
  v_pk_add_f32 v[122:123], v[122:123], v[10:11]
  v_pk_fma_f32 v[14:15], v[122:123], v[122:123], v[14:15]
  v_lshlrev_b32 v124, 16, v62
  v_and_b32 v125, 0xffff0000, v62
  v_pk_add_f32 v[124:125], v[124:125], v[10:11]
  v_pk_fma_f32 v[12:13], v[124:125], v[124:125], v[12:13]
  v_lshlrev_b32 v126, 16, v63
  v_and_b32 v127, 0xffff0000, v63
  v_pk_add_f32 v[126:127], v[126:127], v[10:11]
  v_pk_fma_f32 v[14:15], v[126:127], v[126:127], v[14:15]
  v_add_f32 v12, v12, v13
  v_add_f32 v14, v14, v15
  v_add_f32 v12, v12, v14
  s_nop 1
  v_add_f32_dpp v12, v12, v12 quad_perm:[1,0,3,2] row_mask:0xf bank_mask:0xf
  s_nop 1
  v_add_f32_dpp v12, v12, v12 quad_perm:[2,3,0,1] row_mask:0xf bank_mask:0xf
  s_nop 1
  v_add_f32_dpp v12, v12, v12 row_half_mirror row_mask:0xf bank_mask:0xf
  v_sub_f32 v13, v8, v9
  v_mul_f32 v13, v13, v13
  v_mul_f32 v12, 0x3b000000, v12
  v_sub_f32 v12, v12, v13
  v_max_f32 v12, 0, v12
  v_cvt_pk_bf16_f32 v12, v12, v12
  v_lshlrev_b32 v12, 16, v12
  v_add_f32 v12, 0x3727c5ac, v12
  v_cvt_pk_bf16_f32 v12, v12, v12
  v_lshlrev_b32 v12, 16, v12
  v_sqrt_f32 v12, v12
  s_nop 0
  v_cvt_pk_bf16_f32 v12, v12, v12
  v_lshlrev_b32 v12, 16, v12
  v_rcp_f32 v12, v12
  s_nop 0
  v_mov_b32 v13, v12
  v_cvt_pk_bf16_f32 v32, v64, v65
  v_lshlrev_b32 v64, 16, v32
  v_and_b32 v65, 0xffff0000, v32
  v_pk_mul_f32 v[64:65], v[64:65], v[12:13]
  v_cvt_pk_bf16_f32 v32, v64, v65
  v_cvt_pk_bf16_f32 v33, v66, v67
  v_lshlrev_b32 v66, 16, v33
  v_and_b32 v67, 0xffff0000, v33
  v_pk_mul_f32 v[66:67], v[66:67], v[12:13]
  v_cvt_pk_bf16_f32 v33, v66, v67
  v_cvt_pk_bf16_f32 v34, v68, v69
  v_lshlrev_b32 v68, 16, v34
  v_and_b32 v69, 0xffff0000, v34
  v_pk_mul_f32 v[68:69], v[68:69], v[12:13]
  v_cvt_pk_bf16_f32 v34, v68, v69
  v_cvt_pk_bf16_f32 v35, v70, v71
  v_lshlrev_b32 v70, 16, v35
  v_and_b32 v71, 0xffff0000, v35
  v_pk_mul_f32 v[70:71], v[70:71], v[12:13]
  v_cvt_pk_bf16_f32 v35, v70, v71
  v_cvt_pk_bf16_f32 v36, v72, v73
  v_lshlrev_b32 v72, 16, v36
  v_and_b32 v73, 0xffff0000, v36
  v_pk_mul_f32 v[72:73], v[72:73], v[12:13]
  v_cvt_pk_bf16_f32 v36, v72, v73
  v_cvt_pk_bf16_f32 v37, v74, v75
  v_lshlrev_b32 v74, 16, v37
  v_and_b32 v75, 0xffff0000, v37
  v_pk_mul_f32 v[74:75], v[74:75], v[12:13]
  v_cvt_pk_bf16_f32 v37, v74, v75
  v_cvt_pk_bf16_f32 v38, v76, v77
  v_lshlrev_b32 v76, 16, v38
  v_and_b32 v77, 0xffff0000, v38
  v_pk_mul_f32 v[76:77], v[76:77], v[12:13]
  v_cvt_pk_bf16_f32 v38, v76, v77
  v_cvt_pk_bf16_f32 v39, v78, v79
  v_lshlrev_b32 v78, 16, v39
  v_and_b32 v79, 0xffff0000, v39
  v_pk_mul_f32 v[78:79], v[78:79], v[12:13]
  v_cvt_pk_bf16_f32 v39, v78, v79
  v_cvt_pk_bf16_f32 v40, v80, v81
  v_lshlrev_b32 v80, 16, v40
  v_and_b32 v81, 0xffff0000, v40
  v_pk_mul_f32 v[80:81], v[80:81], v[12:13]
  v_cvt_pk_bf16_f32 v40, v80, v81
  v_cvt_pk_bf16_f32 v41, v82, v83
  v_lshlrev_b32 v82, 16, v41
  v_and_b32 v83, 0xffff0000, v41
  v_pk_mul_f32 v[82:83], v[82:83], v[12:13]
  v_cvt_pk_bf16_f32 v41, v82, v83
  v_cvt_pk_bf16_f32 v42, v84, v85
  v_lshlrev_b32 v84, 16, v42
  v_and_b32 v85, 0xffff0000, v42
  v_pk_mul_f32 v[84:85], v[84:85], v[12:13]
  v_cvt_pk_bf16_f32 v42, v84, v85
  v_cvt_pk_bf16_f32 v43, v86, v87
  v_lshlrev_b32 v86, 16, v43
  v_and_b32 v87, 0xffff0000, v43
  v_pk_mul_f32 v[86:87], v[86:87], v[12:13]
  v_cvt_pk_bf16_f32 v43, v86, v87
  v_cvt_pk_bf16_f32 v44, v88, v89
  v_lshlrev_b32 v88, 16, v44
  v_and_b32 v89, 0xffff0000, v44
  v_pk_mul_f32 v[88:89], v[88:89], v[12:13]
  v_cvt_pk_bf16_f32 v44, v88, v89
  v_cvt_pk_bf16_f32 v45, v90, v91
  v_lshlrev_b32 v90, 16, v45
  v_and_b32 v91, 0xffff0000, v45
  v_pk_mul_f32 v[90:91], v[90:91], v[12:13]
  v_cvt_pk_bf16_f32 v45, v90, v91
  v_cvt_pk_bf16_f32 v46, v92, v93
  v_lshlrev_b32 v92, 16, v46
  v_and_b32 v93, 0xffff0000, v46
  v_pk_mul_f32 v[92:93], v[92:93], v[12:13]
  v_cvt_pk_bf16_f32 v46, v92, v93
  v_cvt_pk_bf16_f32 v47, v94, v95
  v_lshlrev_b32 v94, 16, v47
  v_and_b32 v95, 0xffff0000, v47
  v_pk_mul_f32 v[94:95], v[94:95], v[12:13]
  v_cvt_pk_bf16_f32 v47, v94, v95
  v_cvt_pk_bf16_f32 v48, v96, v97
  v_lshlrev_b32 v96, 16, v48
  v_and_b32 v97, 0xffff0000, v48
  v_pk_mul_f32 v[96:97], v[96:97], v[12:13]
  v_cvt_pk_bf16_f32 v48, v96, v97
  v_cvt_pk_bf16_f32 v49, v98, v99
  v_lshlrev_b32 v98, 16, v49
  v_and_b32 v99, 0xffff0000, v49
  v_pk_mul_f32 v[98:99], v[98:99], v[12:13]
  v_cvt_pk_bf16_f32 v49, v98, v99
  v_cvt_pk_bf16_f32 v50, v100, v101
  v_lshlrev_b32 v100, 16, v50
  v_and_b32 v101, 0xffff0000, v50
  v_pk_mul_f32 v[100:101], v[100:101], v[12:13]
  v_cvt_pk_bf16_f32 v50, v100, v101
  v_cvt_pk_bf16_f32 v51, v102, v103
  v_lshlrev_b32 v102, 16, v51
  v_and_b32 v103, 0xffff0000, v51
  v_pk_mul_f32 v[102:103], v[102:103], v[12:13]
  v_cvt_pk_bf16_f32 v51, v102, v103
  v_cvt_pk_bf16_f32 v52, v104, v105
  v_lshlrev_b32 v104, 16, v52
  v_and_b32 v105, 0xffff0000, v52
  v_pk_mul_f32 v[104:105], v[104:105], v[12:13]
  v_cvt_pk_bf16_f32 v52, v104, v105
  v_cvt_pk_bf16_f32 v53, v106, v107
  v_lshlrev_b32 v106, 16, v53
  v_and_b32 v107, 0xffff0000, v53
  v_pk_mul_f32 v[106:107], v[106:107], v[12:13]
  v_cvt_pk_bf16_f32 v53, v106, v107
  v_cvt_pk_bf16_f32 v54, v108, v109
  v_lshlrev_b32 v108, 16, v54
  v_and_b32 v109, 0xffff0000, v54
  v_pk_mul_f32 v[108:109], v[108:109], v[12:13]
  v_cvt_pk_bf16_f32 v54, v108, v109
  v_cvt_pk_bf16_f32 v55, v110, v111
  v_lshlrev_b32 v110, 16, v55
  v_and_b32 v111, 0xffff0000, v55
  v_pk_mul_f32 v[110:111], v[110:111], v[12:13]
  v_cvt_pk_bf16_f32 v55, v110, v111
  v_cvt_pk_bf16_f32 v56, v112, v113
  v_lshlrev_b32 v112, 16, v56
  v_and_b32 v113, 0xffff0000, v56
  v_pk_mul_f32 v[112:113], v[112:113], v[12:13]
  v_cvt_pk_bf16_f32 v56, v112, v113
  v_cvt_pk_bf16_f32 v57, v114, v115
  v_lshlrev_b32 v114, 16, v57
  v_and_b32 v115, 0xffff0000, v57
  v_pk_mul_f32 v[114:115], v[114:115], v[12:13]
  v_cvt_pk_bf16_f32 v57, v114, v115
  v_cvt_pk_bf16_f32 v58, v116, v117
  v_lshlrev_b32 v116, 16, v58
  v_and_b32 v117, 0xffff0000, v58
  v_pk_mul_f32 v[116:117], v[116:117], v[12:13]
  v_cvt_pk_bf16_f32 v58, v116, v117
  v_cvt_pk_bf16_f32 v59, v118, v119
  v_lshlrev_b32 v118, 16, v59
  v_and_b32 v119, 0xffff0000, v59
  v_pk_mul_f32 v[118:119], v[118:119], v[12:13]
  v_cvt_pk_bf16_f32 v59, v118, v119
  v_cvt_pk_bf16_f32 v60, v120, v121
  v_lshlrev_b32 v120, 16, v60
  v_and_b32 v121, 0xffff0000, v60
  v_pk_mul_f32 v[120:121], v[120:121], v[12:13]
  v_cvt_pk_bf16_f32 v60, v120, v121
  v_cvt_pk_bf16_f32 v61, v122, v123
  v_lshlrev_b32 v122, 16, v61
  v_and_b32 v123, 0xffff0000, v61
  v_pk_mul_f32 v[122:123], v[122:123], v[12:13]
  v_cvt_pk_bf16_f32 v61, v122, v123
  v_cvt_pk_bf16_f32 v62, v124, v125
  v_lshlrev_b32 v124, 16, v62
  v_and_b32 v125, 0xffff0000, v62
  v_pk_mul_f32 v[124:125], v[124:125], v[12:13]
  v_cvt_pk_bf16_f32 v62, v124, v125
  v_cvt_pk_bf16_f32 v63, v126, v127
  v_lshlrev_b32 v126, 16, v63
  v_and_b32 v127, 0xffff0000, v63
  v_pk_mul_f32 v[126:127], v[126:127], v[12:13]
  v_cvt_pk_bf16_f32 v63, v126, v127
  v_add_u32 v14, s29, v2
  v_lshrrev_b32 v15, 1, v14
  v_and_b32 v15, 7, v15
  v_xor_b32 v15, v15, v3
  v_lshlrev_b32 v14, 7, v14
  v_lshl_add_u32 v14, v15, 4, v14
  v_add_u32 v14, 0x10000, v14
  ds_write_b128 v14, v[32:35] offset:0
  ds_write_b128 v14, v[36:39] offset:8192
  ds_write_b128 v14, v[40:43] offset:16384
  ds_write_b128 v14, v[44:47] offset:24576
  ds_write_b128 v14, v[48:51] offset:32768
  ds_write_b128 v14, v[52:55] offset:40960
  ds_write_b128 v14, v[56:59] offset:49152
  ds_write_b128 v14, v[60:63] offset:57344
  s_and_b32 s35, s15, 1
  s_lshr_b32 s36, s15, 1
  v_and_b32 v16, 31, v0
  v_lshrrev_b32 v17, 5, v0
  s_lshl_b32 s37, s35, 5
  v_add_u32 v18, s37, v16
  v_lshrrev_b32 v19, 1, v18
  v_and_b32 v19, 7, v19
  v_xor_b32 v19, v19, v17
  v_lshlrev_b32 v18, 7, v18
  v_lshl_add_u32 v20, v19, 4, v18
  v_add_u32 v20, 65536, v20
  v_xor_b32 v21, 32, v20
  v_xor_b32 v22, 64, v20
  v_xor_b32 v23, 96, v20
  s_lshl_b32 s37, s36, 5
  v_add_u32 v18, s37, v16
  v_lshrrev_b32 v19, 1, v18
  v_and_b32 v19, 7, v19
  v_xor_b32 v19, v19, v17
  v_lshlrev_b32 v18, 7, v18
  v_lshl_add_u32 v24, v19, 4, v18
  v_xor_b32 v25, 32, v24
  v_xor_b32 v26, 64, v24
  v_xor_b32 v27, 96, v24
  v_mov_b32 v96, 0
  v_mov_b32 v97, 0
  v_mov_b32 v98, 0
  v_mov_b32 v99, 0
  v_mov_b32 v100, 0
  v_mov_b32 v101, 0
  v_mov_b32 v102, 0
  v_mov_b32 v103, 0
  v_mov_b32 v104, 0
  v_mov_b32 v105, 0
  v_mov_b32 v106, 0
  v_mov_b32 v107, 0
  v_mov_b32 v108, 0
  v_mov_b32 v109, 0
  v_mov_b32 v110, 0
  v_mov_b32 v111, 0
  s_waitcnt vmcnt(6) lgkmcnt(0)
  s_barrier
  ds_read_b128 v[64:67], v20 offset:0
  ds_read_b128 v[80:83], v24 offset:0
  ds_read_b128 v[68:71], v21 offset:0
  ds_read_b128 v[84:87], v25 offset:0
  ds_read_b128 v[72:75], v22 offset:0
  ds_read_b128 v[88:91], v26 offset:0
  ds_read_b128 v[76:79], v23 offset:0
  ds_read_b128 v[92:95], v27 offset:0
  s_waitcnt lgkmcnt(6)
  v_mfma_f32_32x32x16_bf16 v[96:111], v[64:67], v[80:83], v[96:111]
  s_waitcnt lgkmcnt(4)
  v_mfma_f32_32x32x16_bf16 v[96:111], v[68:71], v[84:87], v[96:111]
  s_waitcnt lgkmcnt(2)
  v_mfma_f32_32x32x16_bf16 v[96:111], v[72:75], v[88:91], v[96:111]
  s_waitcnt lgkmcnt(0)
  v_mfma_f32_32x32x16_bf16 v[96:111], v[76:79], v[92:95], v[96:111]
  s_waitcnt vmcnt(4) lgkmcnt(0)
  s_barrier
  s_mov_b32 s33, 512
  s_add_u32 m0, s32, 0
  s_nop 0
  buffer_load_dwordx4 v5, s[20:23], s33 offen lds
  s_add_u32 m0, s32, 1024
  s_nop 0
  buffer_load_dwordx4 v6, s[20:23], s33 offen lds
  ds_read_b128 v[64:67], v20 offset:8192
  ds_read_b128 v[80:83], v24 offset:16384
  ds_read_b128 v[68:71], v21 offset:8192
  ds_read_b128 v[84:87], v25 offset:16384
  ds_read_b128 v[72:75], v22 offset:8192
  ds_read_b128 v[88:91], v26 offset:16384
  ds_read_b128 v[76:79], v23 offset:8192
  ds_read_b128 v[92:95], v27 offset:16384
  s_waitcnt lgkmcnt(6)
  v_mfma_f32_32x32x16_bf16 v[96:111], v[64:67], v[80:83], v[96:111]
  s_waitcnt lgkmcnt(4)
  v_mfma_f32_32x32x16_bf16 v[96:111], v[68:71], v[84:87], v[96:111]
  s_waitcnt lgkmcnt(2)
  v_mfma_f32_32x32x16_bf16 v[96:111], v[72:75], v[88:91], v[96:111]
  s_waitcnt lgkmcnt(0)
  v_mfma_f32_32x32x16_bf16 v[96:111], v[76:79], v[92:95], v[96:111]
  s_waitcnt vmcnt(4) lgkmcnt(0)
  s_barrier
  s_mov_b32 s33, 640
  s_add_u32 m0, s32, 16384
  s_nop 0
  buffer_load_dwordx4 v5, s[20:23], s33 offen lds
  s_add_u32 m0, s32, 17408
  s_nop 0
  buffer_load_dwordx4 v6, s[20:23], s33 offen lds
  ds_read_b128 v[64:67], v20 offset:16384
  ds_read_b128 v[80:83], v24 offset:32768
  ds_read_b128 v[68:71], v21 offset:16384
  ds_read_b128 v[84:87], v25 offset:32768
  ds_read_b128 v[72:75], v22 offset:16384
  ds_read_b128 v[88:91], v26 offset:32768
  ds_read_b128 v[76:79], v23 offset:16384
  ds_read_b128 v[92:95], v27 offset:32768
  s_waitcnt lgkmcnt(6)
  v_mfma_f32_32x32x16_bf16 v[96:111], v[64:67], v[80:83], v[96:111]
  s_waitcnt lgkmcnt(4)
  v_mfma_f32_32x32x16_bf16 v[96:111], v[68:71], v[84:87], v[96:111]
  s_waitcnt lgkmcnt(2)
  v_mfma_f32_32x32x16_bf16 v[96:111], v[72:75], v[88:91], v[96:111]
  s_waitcnt lgkmcnt(0)
  v_mfma_f32_32x32x16_bf16 v[96:111], v[76:79], v[92:95], v[96:111]
  s_waitcnt vmcnt(4) lgkmcnt(0)
  s_barrier
  s_mov_b32 s33, 768
  s_add_u32 m0, s32, 32768
  s_nop 0
  buffer_load_dwordx4 v5, s[20:23], s33 offen lds
  s_add_u32 m0, s32, 33792
  s_nop 0
  buffer_load_dwordx4 v6, s[20:23], s33 offen lds
  ds_read_b128 v[64:67], v20 offset:24576
  ds_read_b128 v[80:83], v24 offset:49152
  ds_read_b128 v[68:71], v21 offset:24576
  ds_read_b128 v[84:87], v25 offset:49152
  ds_read_b128 v[72:75], v22 offset:24576
  ds_read_b128 v[88:91], v26 offset:49152
  ds_read_b128 v[76:79], v23 offset:24576
  ds_read_b128 v[92:95], v27 offset:49152
  s_waitcnt lgkmcnt(6)
  v_mfma_f32_32x32x16_bf16 v[96:111], v[64:67], v[80:83], v[96:111]
  s_waitcnt lgkmcnt(4)
  v_mfma_f32_32x32x16_bf16 v[96:111], v[68:71], v[84:87], v[96:111]
  s_waitcnt lgkmcnt(2)
  v_mfma_f32_32x32x16_bf16 v[96:111], v[72:75], v[88:91], v[96:111]
  s_waitcnt lgkmcnt(0)
  v_mfma_f32_32x32x16_bf16 v[96:111], v[76:79], v[92:95], v[96:111]
  s_waitcnt vmcnt(4) lgkmcnt(0)
  s_barrier
  s_mov_b32 s33, 896
  s_add_u32 m0, s32, 49152
  s_nop 0
  buffer_load_dwordx4 v5, s[20:23], s33 offen lds
  s_add_u32 m0, s32, 50176
  s_nop 0
  buffer_load_dwordx4 v6, s[20:23], s33 offen lds
  ds_read_b128 v[64:67], v20 offset:32768
  ds_read_b128 v[80:83], v24 offset:0
  ds_read_b128 v[68:71], v21 offset:32768
  ds_read_b128 v[84:87], v25 offset:0
  ds_read_b128 v[72:75], v22 offset:32768
  ds_read_b128 v[88:91], v26 offset:0
  ds_read_b128 v[76:79], v23 offset:32768
  ds_read_b128 v[92:95], v27 offset:0
  s_waitcnt lgkmcnt(6)
  v_mfma_f32_32x32x16_bf16 v[96:111], v[64:67], v[80:83], v[96:111]
  s_waitcnt lgkmcnt(4)
  v_mfma_f32_32x32x16_bf16 v[96:111], v[68:71], v[84:87], v[96:111]
  s_waitcnt lgkmcnt(2)
  v_mfma_f32_32x32x16_bf16 v[96:111], v[72:75], v[88:91], v[96:111]
  s_waitcnt lgkmcnt(0)
  v_mfma_f32_32x32x16_bf16 v[96:111], v[76:79], v[92:95], v[96:111]
  s_waitcnt vmcnt(4) lgkmcnt(0)
  s_barrier
  ds_read_b128 v[64:67], v20 offset:40960
  ds_read_b128 v[80:83], v24 offset:16384
  ds_read_b128 v[68:71], v21 offset:40960
  ds_read_b128 v[84:87], v25 offset:16384
  ds_read_b128 v[72:75], v22 offset:40960
  ds_read_b128 v[88:91], v26 offset:16384
  ds_read_b128 v[76:79], v23 offset:40960
  ds_read_b128 v[92:95], v27 offset:16384
  s_waitcnt lgkmcnt(6)
  v_mfma_f32_32x32x16_bf16 v[96:111], v[64:67], v[80:83], v[96:111]
  s_waitcnt lgkmcnt(4)
  v_mfma_f32_32x32x16_bf16 v[96:111], v[68:71], v[84:87], v[96:111]
  s_waitcnt lgkmcnt(2)
  v_mfma_f32_32x32x16_bf16 v[96:111], v[72:75], v[88:91], v[96:111]
  s_waitcnt lgkmcnt(0)
  v_mfma_f32_32x32x16_bf16 v[96:111], v[76:79], v[92:95], v[96:111]
  s_waitcnt vmcnt(2) lgkmcnt(0)
  s_barrier
  ds_read_b128 v[64:67], v20 offset:49152
  ds_read_b128 v[80:83], v24 offset:32768
  ds_read_b128 v[68:71], v21 offset:49152
  ds_read_b128 v[84:87], v25 offset:32768
  ds_read_b128 v[72:75], v22 offset:49152
  ds_read_b128 v[88:91], v26 offset:32768
  ds_read_b128 v[76:79], v23 offset:49152
  ds_read_b128 v[92:95], v27 offset:32768
  s_waitcnt lgkmcnt(6)
  v_mfma_f32_32x32x16_bf16 v[96:111], v[64:67], v[80:83], v[96:111]
  s_waitcnt lgkmcnt(4)
  v_mfma_f32_32x32x16_bf16 v[96:111], v[68:71], v[84:87], v[96:111]
  s_waitcnt lgkmcnt(2)
  v_mfma_f32_32x32x16_bf16 v[96:111], v[72:75], v[88:91], v[96:111]
  s_waitcnt lgkmcnt(0)
  v_mfma_f32_32x32x16_bf16 v[96:111], v[76:79], v[92:95], v[96:111]
  s_waitcnt vmcnt(0) lgkmcnt(0)
  s_barrier
  ds_read_b128 v[64:67], v20 offset:57344
  ds_read_b128 v[80:83], v24 offset:49152
  ds_read_b128 v[68:71], v21 offset:57344
  ds_read_b128 v[84:87], v25 offset:49152
  ds_read_b128 v[72:75], v22 offset:57344
  ds_read_b128 v[88:91], v26 offset:49152
  ds_read_b128 v[76:79], v23 offset:57344
  ds_read_b128 v[92:95], v27 offset:49152
  s_waitcnt lgkmcnt(6)
  v_mfma_f32_32x32x16_bf16 v[96:111], v[64:67], v[80:83], v[96:111]
  s_waitcnt lgkmcnt(4)
  v_mfma_f32_32x32x16_bf16 v[96:111], v[68:71], v[84:87], v[96:111]
  s_waitcnt lgkmcnt(2)
  v_mfma_f32_32x32x16_bf16 v[96:111], v[72:75], v[88:91], v[96:111]
  s_waitcnt lgkmcnt(0)
  v_mfma_f32_32x32x16_bf16 v[96:111], v[76:79], v[92:95], v[96:111]
  s_lshl_b32 s37, s13, 1
  s_lshr_b32 s38, s36, 1
  s_add_u32 s37, s37, s38
  s_lshl_b32 s37, s37, 5
  s_add_u32 s37, s37, s12
  s_lshl_b32 s37, s37, 13
  s_and_b32 s38, s36, 1
  s_lshl_b32 s38, s38, 5
  v_add_u32 v18, s38, v16
  v_lshrrev_b32 v19, 1, v18
  v_and_b32 v19, 7, v19
  s_lshl_b32 s38, s35, 2
  v_add_u32 v29, s38, v17
  v_xor_b32 v29, v29, v19
  v_lshlrev_b32 v18, 7, v18
  v_lshl_add_u32 v30, v29, 4, v18
  v_xor_b32 v31, 32, v30
  s_nop 7
  v_cvt_pk_bf16_f32 v112, v96, v97
  v_cvt_pk_bf16_f32 v113, v98, v99
  v_cvt_pk_bf16_f32 v114, v100, v101
  v_cvt_pk_bf16_f32 v115, v102, v103
  v_cvt_pk_bf16_f32 v116, v104, v105
  v_cvt_pk_bf16_f32 v117, v106, v107
  v_cvt_pk_bf16_f32 v118, v108, v109
  v_cvt_pk_bf16_f32 v119, v110, v111
  s_nop 1
  v_permlane32_swap_b32 v112, v114
  v_permlane32_swap_b32 v113, v115
  v_permlane32_swap_b32 v116, v118
  v_permlane32_swap_b32 v117, v119
  s_load_dwordx4 s[8:11], s[0:1], 8
  s_lshr_b32 s38, s36, 1
  s_lshl_b32 s38, s38, 13
  s_add_u32 s38, s38, 131072
  v_add_u32 v30, s38, v30
  v_add_u32 v31, s38, v31
  ds_write_b128 v30, v[112:115]
  ds_write_b128 v31, v[116:119]
  v_lshlrev_b32 v29, 4, v0
  s_lshl_b32 s38, s15, 11
  s_add_u32 s39, s38, 131072
  v_add_u32 v28, s39, v29
  s_waitcnt lgkmcnt(0)
  s_barrier
  ds_read_b128 v[64:67], v28
  ds_read_b128 v[68:71], v28 offset:1024
  s_lshl_b32 s37, s13, 1
  s_lshr_b32 s39, s15, 2
  s_add_u32 s37, s37, s39
  s_lshl_b32 s37, s37, 5
  s_add_u32 s37, s37, s12
  s_lshl_b32 s37, s37, 13
  s_and_b32 s39, s15, 3
  s_lshl_b32 s39, s39, 11
  s_add_u32 s37, s37, s39
  s_waitcnt lgkmcnt(1)
  buffer_store_dwordx4 v[64:67], v29, s[24:27], s37 offen sc1
  s_waitcnt lgkmcnt(0)
  buffer_store_dwordx4 v[68:71], v29, s[24:27], s37 offen offset:1024 sc1
  s_lshl_b32 s70, s13, 5
  s_add_u32 s70, s70, s12
  s_lshl_b32 s70, s70, 2
  s_add_u32 s70, s70, 8589312
  s_mov_b32 s71, s15
  s_and_b32 s12, s2, 7
  s_lshr_b32 s13, s2, 3
  s_lshr_b32 s14, s12, 2
  s_and_b32 s12, s12, 3
  s_lshl_b32 s12, s12, 2
  s_lshr_b32 s15, s13, 3
  s_add_u32 s12, s12, s15
  s_and_b32 s13, s13, 7
  s_mov_b32 s15, s71
  v_lshrrev_b32 v2, 3, v0
  v_and_b32 v3, 7, v0
  s_waitcnt lgkmcnt(0)
  s_cmp_eq_u32 s14, 0
  s_cselect_b32 s16, s8, s10
  s_cselect_b32 s17, s9, s11
  s_mov_b32 s18, 8388608
  s_mov_b32 s19, 0x00020000
  s_mov_b32 s20, s6
  s_mov_b32 s21, s7
  s_mov_b32 s22, 9437184
  s_mov_b32 s23, 0x00020000
  s_cmp_lt_u32 s15, 4
  s_cbranch_scc1 k2_consumer
k2_loader:
  s_sub_u32 s15, s15, 4
  s_lshl_b32 s24, s15, 5
  s_add_u32 s24, s24, 0
  v_add_u32 v10, s24, v2
  v_lshrrev_b32 v11, 1, v10
  v_and_b32 v11, 7, v11
  v_xor_b32 v11, v11, v3
  s_lshl_b32 s24, s12, 7
  v_add_u32 v10, s24, v10
  v_lshlrev_b32 v10, 12, v10
  v_lshl_add_u32 v4, v11, 4, v10
  s_lshl_b32 s24, s15, 5
  s_add_u32 s24, s24, 8
  v_add_u32 v10, s24, v2
  v_lshrrev_b32 v11, 1, v10
  v_and_b32 v11, 7, v11
  v_xor_b32 v11, v11, v3
  s_lshl_b32 s24, s12, 7
  v_add_u32 v10, s24, v10
  v_lshlrev_b32 v10, 12, v10
  v_lshl_add_u32 v5, v11, 4, v10
  s_lshl_b32 s24, s15, 5
  s_add_u32 s24, s24, 16
  v_add_u32 v10, s24, v2
  v_lshrrev_b32 v11, 1, v10
  v_and_b32 v11, 7, v11
  v_xor_b32 v11, v11, v3
  s_lshl_b32 s24, s12, 7
  v_add_u32 v10, s24, v10
  v_lshlrev_b32 v10, 12, v10
  v_lshl_add_u32 v6, v11, 4, v10
  s_lshl_b32 s24, s15, 5
  s_add_u32 s24, s24, 24
  v_add_u32 v10, s24, v2
  v_lshrrev_b32 v11, 1, v10
  v_and_b32 v11, 7, v11
  v_xor_b32 v11, v11, v3
  s_lshl_b32 s24, s12, 7
  v_add_u32 v10, s24, v10
  v_lshlrev_b32 v10, 12, v10
  v_lshl_add_u32 v7, v11, 4, v10
  s_lshl_b32 s24, s15, 11
  v_lshlrev_b32 v8, 4, v0
  v_add_u32 v8, s24, v8
  v_add_u32 v9, 1024, v8
  s_mov_b32 s25, 0
  s_lshl_b32 s26, s14, 3
  s_add_u32 s26, s26, s13
  s_lshl_b32 s26, s26, 18
  s_lshl_b32 s27, s15, 12
  s_lshl_b32 s28, s15, 11
  s_add_u32 s28, s28, 98304
  s_mov_b32 s33, s26
  s_mul_i32 s25, s13, 512
  s_and_b32 s25, s25, 4095
  s_lshl_b32 s29, s25, 6
  s_add_u32 s26, s33, s29
  s_mov_b32 s30, s25
  s_waitcnt vmcnt(0)
  s_barrier
  s_add_u32 m0, s27, 0
  s_nop 0
  buffer_load_dwordx4 v4, s[16:19], s25 offen lds
  s_add_u32 m0, s27, 1024
  s_nop 0
  buffer_load_dwordx4 v5, s[16:19], s25 offen lds
  s_add_u32 m0, s27, 2048
  s_nop 0
  buffer_load_dwordx4 v6, s[16:19], s25 offen lds
  s_add_u32 m0, s27, 3072
  s_nop 0
  buffer_load_dwordx4 v7, s[16:19], s25 offen lds
  s_add_u32 s25, s25, 128
  s_and_b32 s25, s25, 4095
  s_lshl_b32 s29, s25, 6
  s_add_u32 s26, s33, s29
  s_add_u32 m0, s27, 16384
  s_nop 0
  buffer_load_dwordx4 v4, s[16:19], s25 offen lds
  s_add_u32 m0, s27, 17408
  s_nop 0
  buffer_load_dwordx4 v5, s[16:19], s25 offen lds
  s_add_u32 m0, s27, 18432
  s_nop 0
  buffer_load_dwordx4 v6, s[16:19], s25 offen lds
  s_add_u32 m0, s27, 19456
  s_nop 0
  buffer_load_dwordx4 v7, s[16:19], s25 offen lds
  s_add_u32 s25, s25, 128
  s_and_b32 s25, s25, 4095
  s_lshl_b32 s29, s25, 6
  s_add_u32 s26, s33, s29
  s_add_u32 m0, s27, 32768
  s_nop 0
  buffer_load_dwordx4 v4, s[16:19], s25 offen lds
  s_add_u32 m0, s27, 33792
  s_nop 0
  buffer_load_dwordx4 v5, s[16:19], s25 offen lds
  s_add_u32 m0, s27, 34816
  s_nop 0
  buffer_load_dwordx4 v6, s[16:19], s25 offen lds
  s_add_u32 m0, s27, 35840
  s_nop 0
  buffer_load_dwordx4 v7, s[16:19], s25 offen lds
  s_add_u32 s25, s25, 128
  s_and_b32 s25, s25, 4095
  s_lshl_b32 s29, s25, 6
  s_add_u32 s26, s33, s29
  s_add_u32 m0, s27, 49152
  s_nop 0
  buffer_load_dwordx4 v4, s[16:19], s25 offen lds
  s_add_u32 m0, s27, 50176
  s_nop 0
  buffer_load_dwordx4 v5, s[16:19], s25 offen lds
  s_add_u32 m0, s27, 51200
  s_nop 0
  buffer_load_dwordx4 v6, s[16:19], s25 offen lds
  s_add_u32 m0, s27, 52224
  s_nop 0
  buffer_load_dwordx4 v7, s[16:19], s25 offen lds
  s_add_u32 s25, s25, 128
  s_and_b32 s25, s25, 4095
  s_lshl_b32 s29, s25, 6
  s_add_u32 s26, s33, s29
  s_add_u32 m0, s27, 65536
  s_nop 0
  buffer_load_dwordx4 v4, s[16:19], s25 offen lds
  s_add_u32 m0, s27, 66560
  s_nop 0
  buffer_load_dwordx4 v5, s[16:19], s25 offen lds
  s_add_u32 m0, s27, 67584
  s_nop 0
  buffer_load_dwordx4 v6, s[16:19], s25 offen lds
  s_add_u32 m0, s27, 68608
  s_nop 0
  buffer_load_dwordx4 v7, s[16:19], s25 offen lds
  s_add_u32 s25, s25, 128
  s_and_b32 s25, s25, 4095
  s_lshl_b32 s29, s25, 6
  s_add_u32 s26, s33, s29
  s_add_u32 m0, s27, 81920
  s_nop 0
  buffer_load_dwordx4 v4, s[16:19], s25 offen lds
  s_add_u32 m0, s27, 82944
  s_nop 0
  buffer_load_dwordx4 v5, s[16:19], s25 offen lds
  s_add_u32 m0, s27, 83968
  s_nop 0
  buffer_load_dwordx4 v6, s[16:19], s25 offen lds
  s_add_u32 m0, s27, 84992
  s_nop 0
  buffer_load_dwordx4 v7, s[16:19], s25 offen lds
  s_add_u32 s25, s25, 128
  s_and_b32 s25, s25, 4095
  s_lshl_b32 s29, s25, 6
  s_add_u32 s26, s33, s29
  s_barrier
  s_lshl_b32 s29, s30, 6
  s_add_u32 s31, s33, s29
  s_add_u32 m0, s28, 0
  s_nop 0
  buffer_load_dwordx4 v8, s[20:23], s31 offen sc1 lds
  s_add_u32 m0, s28, 1024
  s_nop 0
  buffer_load_dwordx4 v9, s[20:23], s31 offen sc1 lds
  s_add_u32 s30, s30, 128
  s_and_b32 s30, s30, 4095
  s_lshl_b32 s29, s30, 6
  s_add_u32 s31, s33, s29
  s_add_u32 m0, s28, 8192
  s_nop 0
  buffer_load_dwordx4 v8, s[20:23], s31 offen sc1 lds
  s_add_u32 m0, s28, 9216
  s_nop 0
  buffer_load_dwordx4 v9, s[20:23], s31 offen sc1 lds
  s_add_u32 s30, s30, 128
  s_and_b32 s30, s30, 4095
  s_lshl_b32 s29, s30, 6
  s_add_u32 s31, s33, s29
  s_add_u32 m0, s28, 16384
  s_nop 0
  buffer_load_dwordx4 v8, s[20:23], s31 offen sc1 lds
  s_add_u32 m0, s28, 17408
  s_nop 0
  buffer_load_dwordx4 v9, s[20:23], s31 offen sc1 lds
  s_add_u32 s30, s30, 128
  s_and_b32 s30, s30, 4095
  s_lshl_b32 s29, s30, 6
  s_add_u32 s31, s33, s29
  s_add_u32 m0, s28, 24576
  s_nop 0
  buffer_load_dwordx4 v8, s[20:23], s31 offen sc1 lds
  s_add_u32 m0, s28, 25600
  s_nop 0
  buffer_load_dwordx4 v9, s[20:23], s31 offen sc1 lds
  s_add_u32 s30, s30, 128
  s_and_b32 s30, s30, 4095
  s_lshl_b32 s29, s30, 6
  s_add_u32 s31, s33, s29
  s_add_u32 m0, s28, 32768
  s_nop 0
  buffer_load_dwordx4 v8, s[20:23], s31 offen sc1 lds
  s_add_u32 m0, s28, 33792
  s_nop 0
  buffer_load_dwordx4 v9, s[20:23], s31 offen sc1 lds
  s_add_u32 s30, s30, 128
  s_and_b32 s30, s30, 4095
  s_lshl_b32 s29, s30, 6
  s_add_u32 s31, s33, s29
  s_add_u32 m0, s28, 40960
  s_nop 0
  buffer_load_dwordx4 v8, s[20:23], s31 offen sc1 lds
  s_add_u32 m0, s28, 41984
  s_nop 0
  buffer_load_dwordx4 v9, s[20:23], s31 offen sc1 lds
  s_add_u32 s30, s30, 128
  s_and_b32 s30, s30, 4095
  s_waitcnt vmcnt(10)
  s_barrier
  s_waitcnt vmcnt(8)
  s_barrier
  s_add_u32 m0, s28, 0
  s_nop 0
  buffer_load_dwordx4 v8, s[20:23], s26 offen sc1 lds
  s_add_u32 m0, s28, 1024
  s_nop 0
  buffer_load_dwordx4 v9, s[20:23], s26 offen sc1 lds
  s_add_u32 m0, s27, 0
  s_nop 0
  buffer_load_dwordx4 v4, s[16:19], s25 offen lds
  s_add_u32 m0, s27, 1024
  s_nop 0
  buffer_load_dwordx4 v5, s[16:19], s25 offen lds
  s_add_u32 m0, s27, 2048
  s_nop 0
  buffer_load_dwordx4 v6, s[16:19], s25 offen lds
  s_add_u32 m0, s27, 3072
  s_nop 0
  buffer_load_dwordx4 v7, s[16:19], s25 offen lds
  s_add_u32 s25, s25, 128
  s_and_b32 s25, s25, 4095
  s_lshl_b32 s29, s25, 6
  s_add_u32 s26, s33, s29
  s_waitcnt vmcnt(12)
  s_barrier
  s_add_u32 m0, s28, 8192
  s_nop 0
  buffer_load_dwordx4 v8, s[20:23], s26 offen sc1 lds
  s_add_u32 m0, s28, 9216
  s_nop 0
  buffer_load_dwordx4 v9, s[20:23], s26 offen sc1 lds
  s_add_u32 m0, s27, 16384
  s_nop 0
  buffer_load_dwordx4 v4, s[16:19], s25 offen lds
  s_add_u32 m0, s27, 17408
  s_nop 0
  buffer_load_dwordx4 v5, s[16:19], s25 offen lds
  s_add_u32 m0, s27, 18432
  s_nop 0
  buffer_load_dwordx4 v6, s[16:19], s25 offen lds
  s_add_u32 m0, s27, 19456
  s_nop 0
  buffer_load_dwordx4 v7, s[16:19], s25 offen lds
  s_add_u32 s25, s25, 128
  s_and_b32 s25, s25, 4095
  s_lshl_b32 s29, s25, 6
  s_add_u32 s26, s33, s29
  s_waitcnt vmcnt(16)
  s_barrier
  s_add_u32 m0, s28, 16384
  s_nop 0
  buffer_load_dwordx4 v8, s[20:23], s26 offen sc1 lds
  s_add_u32 m0, s28, 17408
  s_nop 0
  buffer_load_dwordx4 v9, s[20:23], s26 offen sc1 lds
  s_add_u32 m0, s27, 32768
  s_nop 0
  buffer_load_dwordx4 v4, s[16:19], s25 offen lds
  s_add_u32 m0, s27, 33792
  s_nop 0
  buffer_load_dwordx4 v5, s[16:19], s25 offen lds
  s_add_u32 m0, s27, 34816
  s_nop 0
  buffer_load_dwordx4 v6, s[16:19], s25 offen lds
  s_add_u32 m0, s27, 35840
  s_nop 0
  buffer_load_dwordx4 v7, s[16:19], s25 offen lds
  s_add_u32 s25, s25, 128
  s_and_b32 s25, s25, 4095
  s_lshl_b32 s29, s25, 6
  s_add_u32 s26, s33, s29
  s_waitcnt vmcnt(20)
  s_barrier
  s_add_u32 m0, s28, 24576
  s_nop 0
  buffer_load_dwordx4 v8, s[20:23], s26 offen sc1 lds
  s_add_u32 m0, s28, 25600
  s_nop 0
  buffer_load_dwordx4 v9, s[20:23], s26 offen sc1 lds
  s_add_u32 m0, s27, 49152
  s_nop 0
  buffer_load_dwordx4 v4, s[16:19], s25 offen lds
  s_add_u32 m0, s27, 50176
  s_nop 0
  buffer_load_dwordx4 v5, s[16:19], s25 offen lds
  s_add_u32 m0, s27, 51200
  s_nop 0
  buffer_load_dwordx4 v6, s[16:19], s25 offen lds
  s_add_u32 m0, s27, 52224
  s_nop 0
  buffer_load_dwordx4 v7, s[16:19], s25 offen lds
  s_add_u32 s25, s25, 128
  s_and_b32 s25, s25, 4095
  s_lshl_b32 s29, s25, 6
  s_add_u32 s26, s33, s29
  s_waitcnt vmcnt(24)
  s_barrier
  s_add_u32 m0, s28, 32768
  s_nop 0
  buffer_load_dwordx4 v8, s[20:23], s26 offen sc1 lds
  s_add_u32 m0, s28, 33792
  s_nop 0
  buffer_load_dwordx4 v9, s[20:23], s26 offen sc1 lds
  s_add_u32 m0, s27, 65536
  s_nop 0
  buffer_load_dwordx4 v4, s[16:19], s25 offen lds
  s_add_u32 m0, s27, 66560
  s_nop 0
  buffer_load_dwordx4 v5, s[16:19], s25 offen lds
  s_add_u32 m0, s27, 67584
  s_nop 0
  buffer_load_dwordx4 v6, s[16:19], s25 offen lds
  s_add_u32 m0, s27, 68608
  s_nop 0
  buffer_load_dwordx4 v7, s[16:19], s25 offen lds
  s_add_u32 s25, s25, 128
  s_and_b32 s25, s25, 4095
  s_lshl_b32 s29, s25, 6
  s_add_u32 s26, s33, s29
  s_waitcnt vmcnt(24)
  s_barrier
  s_add_u32 m0, s28, 40960
  s_nop 0
  buffer_load_dwordx4 v8, s[20:23], s26 offen sc1 lds
  s_add_u32 m0, s28, 41984
  s_nop 0
  buffer_load_dwordx4 v9, s[20:23], s26 offen sc1 lds
  s_add_u32 m0, s27, 81920
  s_nop 0
  buffer_load_dwordx4 v4, s[16:19], s25 offen lds
  s_add_u32 m0, s27, 82944
  s_nop 0
  buffer_load_dwordx4 v5, s[16:19], s25 offen lds
  s_add_u32 m0, s27, 83968
  s_nop 0
  buffer_load_dwordx4 v6, s[16:19], s25 offen lds
  s_add_u32 m0, s27, 84992
  s_nop 0
  buffer_load_dwordx4 v7, s[16:19], s25 offen lds
  s_add_u32 s25, s25, 128
  s_and_b32 s25, s25, 4095
  s_lshl_b32 s29, s25, 6
  s_add_u32 s26, s33, s29
  s_waitcnt vmcnt(24)
  s_barrier
  s_add_u32 m0, s28, 0
  s_nop 0
  buffer_load_dwordx4 v8, s[20:23], s26 offen sc1 lds
  s_add_u32 m0, s28, 1024
  s_nop 0
  buffer_load_dwordx4 v9, s[20:23], s26 offen sc1 lds
  s_add_u32 m0, s27, 0
  s_nop 0
  buffer_load_dwordx4 v4, s[16:19], s25 offen lds
  s_add_u32 m0, s27, 1024
  s_nop 0
  buffer_load_dwordx4 v5, s[16:19], s25 offen lds
  s_add_u32 m0, s27, 2048
  s_nop 0
  buffer_load_dwordx4 v6, s[16:19], s25 offen lds
  s_add_u32 m0, s27, 3072
  s_nop 0
  buffer_load_dwordx4 v7, s[16:19], s25 offen lds
  s_add_u32 s25, s25, 128
  s_and_b32 s25, s25, 4095
  s_lshl_b32 s29, s25, 6
  s_add_u32 s26, s33, s29
  s_waitcnt vmcnt(24)
  s_barrier
  s_add_u32 m0, s28, 8192
  s_nop 0
  buffer_load_dwordx4 v8, s[20:23], s26 offen sc1 lds
  s_add_u32 m0, s28, 9216
  s_nop 0
  buffer_load_dwordx4 v9, s[20:23], s26 offen sc1 lds
  s_add_u32 m0, s27, 16384
  s_nop 0
  buffer_load_dwordx4 v4, s[16:19], s25 offen lds
  s_add_u32 m0, s27, 17408
  s_nop 0
  buffer_load_dwordx4 v5, s[16:19], s25 offen lds
  s_add_u32 m0, s27, 18432
  s_nop 0
  buffer_load_dwordx4 v6, s[16:19], s25 offen lds
  s_add_u32 m0, s27, 19456
  s_nop 0
  buffer_load_dwordx4 v7, s[16:19], s25 offen lds
  s_add_u32 s25, s25, 128
  s_and_b32 s25, s25, 4095
  s_lshl_b32 s29, s25, 6
  s_add_u32 s26, s33, s29
  s_waitcnt vmcnt(24)
  s_barrier
  s_add_u32 m0, s28, 16384
  s_nop 0
  buffer_load_dwordx4 v8, s[20:23], s26 offen sc1 lds
  s_add_u32 m0, s28, 17408
  s_nop 0
  buffer_load_dwordx4 v9, s[20:23], s26 offen sc1 lds
  s_add_u32 m0, s27, 32768
  s_nop 0
  buffer_load_dwordx4 v4, s[16:19], s25 offen lds
  s_add_u32 m0, s27, 33792
  s_nop 0
  buffer_load_dwordx4 v5, s[16:19], s25 offen lds
  s_add_u32 m0, s27, 34816
  s_nop 0
  buffer_load_dwordx4 v6, s[16:19], s25 offen lds
  s_add_u32 m0, s27, 35840
  s_nop 0
  buffer_load_dwordx4 v7, s[16:19], s25 offen lds
  s_add_u32 s25, s25, 128
  s_and_b32 s25, s25, 4095
  s_lshl_b32 s29, s25, 6
  s_add_u32 s26, s33, s29
  s_waitcnt vmcnt(24)
  s_barrier
  s_add_u32 m0, s28, 24576
  s_nop 0
  buffer_load_dwordx4 v8, s[20:23], s26 offen sc1 lds
  s_add_u32 m0, s28, 25600
  s_nop 0
  buffer_load_dwordx4 v9, s[20:23], s26 offen sc1 lds
  s_add_u32 m0, s27, 49152
  s_nop 0
  buffer_load_dwordx4 v4, s[16:19], s25 offen lds
  s_add_u32 m0, s27, 50176
  s_nop 0
  buffer_load_dwordx4 v5, s[16:19], s25 offen lds
  s_add_u32 m0, s27, 51200
  s_nop 0
  buffer_load_dwordx4 v6, s[16:19], s25 offen lds
  s_add_u32 m0, s27, 52224
  s_nop 0
  buffer_load_dwordx4 v7, s[16:19], s25 offen lds
  s_add_u32 s25, s25, 128
  s_and_b32 s25, s25, 4095
  s_lshl_b32 s29, s25, 6
  s_add_u32 s26, s33, s29
  s_waitcnt vmcnt(24)
  s_barrier
  s_add_u32 m0, s28, 32768
  s_nop 0
  buffer_load_dwordx4 v8, s[20:23], s26 offen sc1 lds
  s_add_u32 m0, s28, 33792
  s_nop 0
  buffer_load_dwordx4 v9, s[20:23], s26 offen sc1 lds
  s_add_u32 m0, s27, 65536
  s_nop 0
  buffer_load_dwordx4 v4, s[16:19], s25 offen lds
  s_add_u32 m0, s27, 66560
  s_nop 0
  buffer_load_dwordx4 v5, s[16:19], s25 offen lds
  s_add_u32 m0, s27, 67584
  s_nop 0
  buffer_load_dwordx4 v6, s[16:19], s25 offen lds
  s_add_u32 m0, s27, 68608
  s_nop 0
  buffer_load_dwordx4 v7, s[16:19], s25 offen lds
  s_add_u32 s25, s25, 128
  s_and_b32 s25, s25, 4095
  s_lshl_b32 s29, s25, 6
  s_add_u32 s26, s33, s29
  s_waitcnt vmcnt(24)
  s_barrier
  s_add_u32 m0, s28, 40960
  s_nop 0
  buffer_load_dwordx4 v8, s[20:23], s26 offen sc1 lds
  s_add_u32 m0, s28, 41984
  s_nop 0
  buffer_load_dwordx4 v9, s[20:23], s26 offen sc1 lds
  s_add_u32 m0, s27, 81920
  s_nop 0
  buffer_load_dwordx4 v4, s[16:19], s25 offen lds
  s_add_u32 m0, s27, 82944
  s_nop 0
  buffer_load_dwordx4 v5, s[16:19], s25 offen lds
  s_add_u32 m0, s27, 83968
  s_nop 0
  buffer_load_dwordx4 v6, s[16:19], s25 offen lds
  s_add_u32 m0, s27, 84992
  s_nop 0
  buffer_load_dwordx4 v7, s[16:19], s25 offen lds
  s_add_u32 s25, s25, 128
  s_and_b32 s25, s25, 4095
  s_lshl_b32 s29, s25, 6
  s_add_u32 s26, s33, s29
  s_waitcnt vmcnt(24)
  s_barrier
  s_add_u32 m0, s28, 0
  s_nop 0
  buffer_load_dwordx4 v8, s[20:23], s26 offen sc1 lds
  s_add_u32 m0, s28, 1024
  s_nop 0
  buffer_load_dwordx4 v9, s[20:23], s26 offen sc1 lds
  s_add_u32 m0, s27, 0
  s_nop 0
  buffer_load_dwordx4 v4, s[16:19], s25 offen lds
  s_add_u32 m0, s27, 1024
  s_nop 0
  buffer_load_dwordx4 v5, s[16:19], s25 offen lds
  s_add_u32 m0, s27, 2048
  s_nop 0
  buffer_load_dwordx4 v6, s[16:19], s25 offen lds
  s_add_u32 m0, s27, 3072
  s_nop 0
  buffer_load_dwordx4 v7, s[16:19], s25 offen lds
  s_add_u32 s25, s25, 128
  s_and_b32 s25, s25, 4095
  s_lshl_b32 s29, s25, 6
  s_add_u32 s26, s33, s29
  s_waitcnt vmcnt(24)
  s_barrier
  s_add_u32 m0, s28, 8192
  s_nop 0
  buffer_load_dwordx4 v8, s[20:23], s26 offen sc1 lds
  s_add_u32 m0, s28, 9216
  s_nop 0
  buffer_load_dwordx4 v9, s[20:23], s26 offen sc1 lds
  s_add_u32 m0, s27, 16384
  s_nop 0
  buffer_load_dwordx4 v4, s[16:19], s25 offen lds
  s_add_u32 m0, s27, 17408
  s_nop 0
  buffer_load_dwordx4 v5, s[16:19], s25 offen lds
  s_add_u32 m0, s27, 18432
  s_nop 0
  buffer_load_dwordx4 v6, s[16:19], s25 offen lds
  s_add_u32 m0, s27, 19456
  s_nop 0
  buffer_load_dwordx4 v7, s[16:19], s25 offen lds
  s_add_u32 s25, s25, 128
  s_and_b32 s25, s25, 4095
  s_lshl_b32 s29, s25, 6
  s_add_u32 s26, s33, s29
  s_waitcnt vmcnt(24)
  s_barrier
  s_add_u32 m0, s28, 16384
  s_nop 0
  buffer_load_dwordx4 v8, s[20:23], s26 offen sc1 lds
  s_add_u32 m0, s28, 17408
  s_nop 0
  buffer_load_dwordx4 v9, s[20:23], s26 offen sc1 lds
  s_add_u32 m0, s27, 32768
  s_nop 0
  buffer_load_dwordx4 v4, s[16:19], s25 offen lds
  s_add_u32 m0, s27, 33792
  s_nop 0
  buffer_load_dwordx4 v5, s[16:19], s25 offen lds
  s_add_u32 m0, s27, 34816
  s_nop 0
  buffer_load_dwordx4 v6, s[16:19], s25 offen lds
  s_add_u32 m0, s27, 35840
  s_nop 0
  buffer_load_dwordx4 v7, s[16:19], s25 offen lds
  s_add_u32 s25, s25, 128
  s_and_b32 s25, s25, 4095
  s_lshl_b32 s29, s25, 6
  s_add_u32 s26, s33, s29
  s_waitcnt vmcnt(24)
  s_barrier
  s_add_u32 m0, s28, 24576
  s_nop 0
  buffer_load_dwordx4 v8, s[20:23], s26 offen sc1 lds
  s_add_u32 m0, s28, 25600
  s_nop 0
  buffer_load_dwordx4 v9, s[20:23], s26 offen sc1 lds
  s_add_u32 m0, s27, 49152
  s_nop 0
  buffer_load_dwordx4 v4, s[16:19], s25 offen lds
  s_add_u32 m0, s27, 50176
  s_nop 0
  buffer_load_dwordx4 v5, s[16:19], s25 offen lds
  s_add_u32 m0, s27, 51200
  s_nop 0
  buffer_load_dwordx4 v6, s[16:19], s25 offen lds
  s_add_u32 m0, s27, 52224
  s_nop 0
  buffer_load_dwordx4 v7, s[16:19], s25 offen lds
  s_add_u32 s25, s25, 128
  s_and_b32 s25, s25, 4095
  s_lshl_b32 s29, s25, 6
  s_add_u32 s26, s33, s29
  s_waitcnt vmcnt(24)
  s_barrier
  s_add_u32 m0, s28, 32768
  s_nop 0
  buffer_load_dwordx4 v8, s[20:23], s26 offen sc1 lds
  s_add_u32 m0, s28, 33792
  s_nop 0
  buffer_load_dwordx4 v9, s[20:23], s26 offen sc1 lds
  s_add_u32 m0, s27, 65536
  s_nop 0
  buffer_load_dwordx4 v4, s[16:19], s25 offen lds
  s_add_u32 m0, s27, 66560
  s_nop 0
  buffer_load_dwordx4 v5, s[16:19], s25 offen lds
  s_add_u32 m0, s27, 67584
  s_nop 0
  buffer_load_dwordx4 v6, s[16:19], s25 offen lds
  s_add_u32 m0, s27, 68608
  s_nop 0
  buffer_load_dwordx4 v7, s[16:19], s25 offen lds
  s_add_u32 s25, s25, 128
  s_and_b32 s25, s25, 4095
  s_lshl_b32 s29, s25, 6
  s_add_u32 s26, s33, s29
  s_waitcnt vmcnt(24)
  s_barrier
  s_add_u32 m0, s28, 40960
  s_nop 0
  buffer_load_dwordx4 v8, s[20:23], s26 offen sc1 lds
  s_add_u32 m0, s28, 41984
  s_nop 0
  buffer_load_dwordx4 v9, s[20:23], s26 offen sc1 lds
  s_add_u32 m0, s27, 81920
  s_nop 0
  buffer_load_dwordx4 v4, s[16:19], s25 offen lds
  s_add_u32 m0, s27, 82944
  s_nop 0
  buffer_load_dwordx4 v5, s[16:19], s25 offen lds
  s_add_u32 m0, s27, 83968
  s_nop 0
  buffer_load_dwordx4 v6, s[16:19], s25 offen lds
  s_add_u32 m0, s27, 84992
  s_nop 0
  buffer_load_dwordx4 v7, s[16:19], s25 offen lds
  s_add_u32 s25, s25, 128
  s_and_b32 s25, s25, 4095
  s_lshl_b32 s29, s25, 6
  s_add_u32 s26, s33, s29
  s_waitcnt vmcnt(24)
  s_barrier
  s_add_u32 m0, s28, 0
  s_nop 0
  buffer_load_dwordx4 v8, s[20:23], s26 offen sc1 lds
  s_add_u32 m0, s28, 1024
  s_nop 0
  buffer_load_dwordx4 v9, s[20:23], s26 offen sc1 lds
  s_add_u32 m0, s27, 0
  s_nop 0
  buffer_load_dwordx4 v4, s[16:19], s25 offen lds
  s_add_u32 m0, s27, 1024
  s_nop 0
  buffer_load_dwordx4 v5, s[16:19], s25 offen lds
  s_add_u32 m0, s27, 2048
  s_nop 0
  buffer_load_dwordx4 v6, s[16:19], s25 offen lds
  s_add_u32 m0, s27, 3072
  s_nop 0
  buffer_load_dwordx4 v7, s[16:19], s25 offen lds
  s_add_u32 s25, s25, 128
  s_and_b32 s25, s25, 4095
  s_lshl_b32 s29, s25, 6
  s_add_u32 s26, s33, s29
  s_waitcnt vmcnt(24)
  s_barrier
  s_add_u32 m0, s28, 8192
  s_nop 0
  buffer_load_dwordx4 v8, s[20:23], s26 offen sc1 lds
  s_add_u32 m0, s28, 9216
  s_nop 0
  buffer_load_dwordx4 v9, s[20:23], s26 offen sc1 lds
  s_add_u32 m0, s27, 16384
  s_nop 0
  buffer_load_dwordx4 v4, s[16:19], s25 offen lds
  s_add_u32 m0, s27, 17408
  s_nop 0
  buffer_load_dwordx4 v5, s[16:19], s25 offen lds
  s_add_u32 m0, s27, 18432
  s_nop 0
  buffer_load_dwordx4 v6, s[16:19], s25 offen lds
  s_add_u32 m0, s27, 19456
  s_nop 0
  buffer_load_dwordx4 v7, s[16:19], s25 offen lds
  s_add_u32 s25, s25, 128
  s_and_b32 s25, s25, 4095
  s_lshl_b32 s29, s25, 6
  s_add_u32 s26, s33, s29
  s_waitcnt vmcnt(24)
  s_barrier
  s_add_u32 m0, s28, 16384
  s_nop 0
  buffer_load_dwordx4 v8, s[20:23], s26 offen sc1 lds
  s_add_u32 m0, s28, 17408
  s_nop 0
  buffer_load_dwordx4 v9, s[20:23], s26 offen sc1 lds
  s_add_u32 m0, s27, 32768
  s_nop 0
  buffer_load_dwordx4 v4, s[16:19], s25 offen lds
  s_add_u32 m0, s27, 33792
  s_nop 0
  buffer_load_dwordx4 v5, s[16:19], s25 offen lds
  s_add_u32 m0, s27, 34816
  s_nop 0
  buffer_load_dwordx4 v6, s[16:19], s25 offen lds
  s_add_u32 m0, s27, 35840
  s_nop 0
  buffer_load_dwordx4 v7, s[16:19], s25 offen lds
  s_add_u32 s25, s25, 128
  s_and_b32 s25, s25, 4095
  s_lshl_b32 s29, s25, 6
  s_add_u32 s26, s33, s29
  s_waitcnt vmcnt(24)
  s_barrier
  s_add_u32 m0, s28, 24576
  s_nop 0
  buffer_load_dwordx4 v8, s[20:23], s26 offen sc1 lds
  s_add_u32 m0, s28, 25600
  s_nop 0
  buffer_load_dwordx4 v9, s[20:23], s26 offen sc1 lds
  s_add_u32 m0, s27, 49152
  s_nop 0
  buffer_load_dwordx4 v4, s[16:19], s25 offen lds
  s_add_u32 m0, s27, 50176
  s_nop 0
  buffer_load_dwordx4 v5, s[16:19], s25 offen lds
  s_add_u32 m0, s27, 51200
  s_nop 0
  buffer_load_dwordx4 v6, s[16:19], s25 offen lds
  s_add_u32 m0, s27, 52224
  s_nop 0
  buffer_load_dwordx4 v7, s[16:19], s25 offen lds
  s_add_u32 s25, s25, 128
  s_and_b32 s25, s25, 4095
  s_lshl_b32 s29, s25, 6
  s_add_u32 s26, s33, s29
  s_waitcnt vmcnt(24)
  s_barrier
  s_add_u32 m0, s28, 32768
  s_nop 0
  buffer_load_dwordx4 v8, s[20:23], s26 offen sc1 lds
  s_add_u32 m0, s28, 33792
  s_nop 0
  buffer_load_dwordx4 v9, s[20:23], s26 offen sc1 lds
  s_add_u32 m0, s27, 65536
  s_nop 0
  buffer_load_dwordx4 v4, s[16:19], s25 offen lds
  s_add_u32 m0, s27, 66560
  s_nop 0
  buffer_load_dwordx4 v5, s[16:19], s25 offen lds
  s_add_u32 m0, s27, 67584
  s_nop 0
  buffer_load_dwordx4 v6, s[16:19], s25 offen lds
  s_add_u32 m0, s27, 68608
  s_nop 0
  buffer_load_dwordx4 v7, s[16:19], s25 offen lds
  s_add_u32 s25, s25, 128
  s_and_b32 s25, s25, 4095
  s_lshl_b32 s29, s25, 6
  s_add_u32 s26, s33, s29
  s_waitcnt vmcnt(24)
  s_barrier
  s_add_u32 m0, s28, 40960
  s_nop 0
  buffer_load_dwordx4 v8, s[20:23], s26 offen sc1 lds
  s_add_u32 m0, s28, 41984
  s_nop 0
  buffer_load_dwordx4 v9, s[20:23], s26 offen sc1 lds
  s_add_u32 m0, s27, 81920
  s_nop 0
  buffer_load_dwordx4 v4, s[16:19], s25 offen lds
  s_add_u32 m0, s27, 82944
  s_nop 0
  buffer_load_dwordx4 v5, s[16:19], s25 offen lds
  s_add_u32 m0, s27, 83968
  s_nop 0
  buffer_load_dwordx4 v6, s[16:19], s25 offen lds
  s_add_u32 m0, s27, 84992
  s_nop 0
  buffer_load_dwordx4 v7, s[16:19], s25 offen lds
  s_add_u32 s25, s25, 128
  s_and_b32 s25, s25, 4095
  s_lshl_b32 s29, s25, 6
  s_add_u32 s26, s33, s29
  s_waitcnt vmcnt(24)
  s_barrier
  s_add_u32 m0, s28, 0
  s_nop 0
  buffer_load_dwordx4 v8, s[20:23], s26 offen sc1 lds
  s_add_u32 m0, s28, 1024
  s_nop 0
  buffer_load_dwordx4 v9, s[20:23], s26 offen sc1 lds
  s_add_u32 m0, s27, 0
  s_nop 0
  buffer_load_dwordx4 v4, s[16:19], s25 offen lds
  s_add_u32 m0, s27, 1024
  s_nop 0
  buffer_load_dwordx4 v5, s[16:19], s25 offen lds
  s_add_u32 m0, s27, 2048
  s_nop 0
  buffer_load_dwordx4 v6, s[16:19], s25 offen lds
  s_add_u32 m0, s27, 3072
  s_nop 0
  buffer_load_dwordx4 v7, s[16:19], s25 offen lds
  s_add_u32 s25, s25, 128
  s_and_b32 s25, s25, 4095
  s_lshl_b32 s29, s25, 6
  s_add_u32 s26, s33, s29
  s_waitcnt vmcnt(24)
  s_barrier
  s_add_u32 m0, s28, 8192
  s_nop 0
  buffer_load_dwordx4 v8, s[20:23], s26 offen sc1 lds
  s_add_u32 m0, s28, 9216
  s_nop 0
  buffer_load_dwordx4 v9, s[20:23], s26 offen sc1 lds
  s_add_u32 m0, s27, 16384
  s_nop 0
  buffer_load_dwordx4 v4, s[16:19], s25 offen lds
  s_add_u32 m0, s27, 17408
  s_nop 0
  buffer_load_dwordx4 v5, s[16:19], s25 offen lds
  s_add_u32 m0, s27, 18432
  s_nop 0
  buffer_load_dwordx4 v6, s[16:19], s25 offen lds
  s_add_u32 m0, s27, 19456
  s_nop 0
  buffer_load_dwordx4 v7, s[16:19], s25 offen lds
  s_add_u32 s25, s25, 128
  s_and_b32 s25, s25, 4095
  s_lshl_b32 s29, s25, 6
  s_add_u32 s26, s33, s29
  s_waitcnt vmcnt(24)
  s_barrier
  s_waitcnt vmcnt(18)
  s_barrier
  s_waitcnt vmcnt(12)
  s_barrier
  s_waitcnt vmcnt(6)
  s_barrier
  s_waitcnt vmcnt(0)
  s_barrier
  s_branch k2_done
k2_consumer:
  s_cmp_lg_u32 s15, 0
  s_cbranch_scc1 f_noep
  v_mov_b32 v158, 0
  s_mov_b32 s69, 0
ep_co:
  buffer_load_dword v159, v158, s[96:99], 0 offen sc1
  s_waitcnt vmcnt(0)
  v_readfirstlane_b32 s68, v159
  s_add_u32 s69, s69, 1
  s_cmp_gt_u32 s69, 4194304
  s_cbranch_scc1 ep_co_ok
  s_cmp_eq_u32 s68, 0
  s_cbranch_scc1 ep_co
ep_co_ok:
  v_mov_b32 v4, s68
  v_mov_b32 v5, 147456
  ds_write_b32 v5, v4
  s_waitcnt lgkmcnt(0)
f_noep:
  s_waitcnt vmcnt(0)
  s_barrier
  s_cmp_lg_u32 s15, 0
  s_cbranch_scc1 f_noflagA
  v_mov_b32 v4, s68
  v_mov_b32 v5, 0
  s_mov_b64 s[36:37], exec
  s_mov_b64 exec, 1
  buffer_store_dword v4, v5, s[20:23], s70 offen sc1
  s_mov_b64 exec, s[36:37]
f_noflagA:
  v_mov_b32 v158, 147456
  ds_read_b32 v159, v158
  s_waitcnt lgkmcnt(0)
  v_readfirstlane_b32 s68, v159
  s_cmp_lg_u32 s15, 1
  s_cbranch_scc1 f_pollA_ok
  s_lshl_b32 s31, s14, 2
  s_lshr_b32 s32, s13, 1
  s_add_u32 s31, s31, s32
  s_lshl_b32 s31, s31, 7
  s_add_u32 s31, s31, 8589312
  v_and_b32 v10, 31, v0
  v_lshlrev_b32 v10, 2, v10
  s_mov_b32 s69, 0
f_pollA:
  buffer_load_dword v11, v10, s[20:23], s31 offen sc1
  s_waitcnt vmcnt(0)
  v_cmp_ne_u32 s[36:37], s68, v11
  s_nop 3
  s_cmp_eq_u64 s[36:37], 0
  s_cbranch_scc1 f_pollA_ok
  s_add_u32 s69, s69, 1
  s_cmp_gt_u32 s69, 4194304
  s_cbranch_scc1 f_pollA_ok
  s_branch f_pollA
f_pollA_ok:
  s_barrier
  v_and_b32 v16, 31, v0
  v_lshrrev_b32 v17, 5, v0
  s_lshl_b32 s24, s15, 5
  v_add_u32 v18, s24, v16
  v_lshrrev_b32 v19, 1, v18
  v_and_b32 v19, 7, v19
  v_xor_b32 v19, v19, v17
  v_lshlrev_b32 v18, 7, v18
  v_lshl_add_u32 v20, v19, 4, v18
  v_xor_b32 v21, 32, v20
  v_xor_b32 v22, 64, v20
  v_xor_b32 v23, 96, v20
  v_add_u32 v28, 0x10000, v20
  v_add_u32 v29, 0x10000, v21
  v_add_u32 v30, 0x10000, v22
  v_add_u32 v31, 0x10000, v23
  v_lshrrev_b32 v19, 1, v16
  v_and_b32 v19, 7, v19
  v_xor_b32 v19, v19, v17
  v_lshlrev_b32 v18, 7, v16
  v_lshl_add_u32 v24, v19, 4, v18
  v_add_u32 v24, 98304, v24
  v_xor_b32 v25, 32, v24
  v_xor_b32 v26, 64, v24
  v_xor_b32 v27, 96, v24
  v_mov_b32 v32, 0
  v_mov_b32 v33, 0
  v_mov_b32 v34, 0
  v_mov_b32 v35, 0
  v_mov_b32 v36, 0
  v_mov_b32 v37, 0
  v_mov_b32 v38, 0
  v_mov_b32 v39, 0
  v_mov_b32 v40, 0
  v_mov_b32 v41, 0
  v_mov_b32 v42, 0
  v_mov_b32 v43, 0
  v_mov_b32 v44, 0
  v_mov_b32 v45, 0
  v_mov_b32 v46, 0
  v_mov_b32 v47, 0
  v_mov_b32 v48, 0
  v_mov_b32 v49, 0
  v_mov_b32 v50, 0
  v_mov_b32 v51, 0
  v_mov_b32 v52, 0
  v_mov_b32 v53, 0
  v_mov_b32 v54, 0
  v_mov_b32 v55, 0
  v_mov_b32 v56, 0
  v_mov_b32 v57, 0
  v_mov_b32 v58, 0
  v_mov_b32 v59, 0
  v_mov_b32 v60, 0
  v_mov_b32 v61, 0
  v_mov_b32 v62, 0
  v_mov_b32 v63, 0
  s_barrier
  ds_read_b128 v[64:67], v20 offset:0
  ds_read_b128 v[80:83], v24 offset:0
  ds_read_b128 v[84:87], v24 offset:4096
  ds_read_b128 v[68:71], v21 offset:0
  ds_read_b128 v[88:91], v25 offset:0
  ds_read_b128 v[92:95], v25 offset:4096
  ds_read_b128 v[72:75], v22 offset:0
  ds_read_b128 v[96:99], v26 offset:0
  ds_read_b128 v[100:103], v26 offset:4096
  ds_read_b128 v[76:79], v23 offset:0
  ds_read_b128 v[104:107], v27 offset:0
  ds_read_b128 v[108:111], v27 offset:4096
  s_waitcnt lgkmcnt(0)
  s_barrier
  v_mfma_f32_32x32x16_bf16 v[32:47], v[80:83], v[64:67], v[32:47]
  ds_read_b128 v[112:115], v20 offset:16384
  ds_read_b128 v[128:131], v24 offset:8192
  ds_read_b128 v[132:135], v24 offset:12288
  v_mfma_f32_32x32x16_bf16 v[48:63], v[84:87], v[64:67], v[48:63]
  ds_read_b128 v[116:119], v21 offset:16384
  ds_read_b128 v[136:139], v25 offset:8192
  ds_read_b128 v[140:143], v25 offset:12288
  v_mfma_f32_32x32x16_bf16 v[32:47], v[88:91], v[68:71], v[32:47]
  ds_read_b128 v[120:123], v22 offset:16384
  ds_read_b128 v[144:147], v26 offset:8192
  ds_read_b128 v[148:151], v26 offset:12288
  v_mfma_f32_32x32x16_bf16 v[48:63], v[92:95], v[68:71], v[48:63]
  ds_read_b128 v[124:127], v23 offset:16384
  ds_read_b128 v[152:155], v27 offset:8192
  ds_read_b128 v[156:159], v27 offset:12288
  v_mfma_f32_32x32x16_bf16 v[32:47], v[96:99], v[72:75], v[32:47]
  v_mfma_f32_32x32x16_bf16 v[48:63], v[100:103], v[72:75], v[48:63]
  v_mfma_f32_32x32x16_bf16 v[32:47], v[104:107], v[76:79], v[32:47]
  v_mfma_f32_32x32x16_bf16 v[48:63], v[108:111], v[76:79], v[48:63]
  s_waitcnt lgkmcnt(0)
  s_barrier
  v_mfma_f32_32x32x16_bf16 v[32:47], v[128:131], v[112:115], v[32:47]
  ds_read_b128 v[64:67], v20 offset:32768
  ds_read_b128 v[80:83], v24 offset:16384
  ds_read_b128 v[84:87], v24 offset:20480
  v_mfma_f32_32x32x16_bf16 v[48:63], v[132:135], v[112:115], v[48:63]
  ds_read_b128 v[68:71], v21 offset:32768
  ds_read_b128 v[88:91], v25 offset:16384
  ds_read_b128 v[92:95], v25 offset:20480
  v_mfma_f32_32x32x16_bf16 v[32:47], v[136:139], v[116:119], v[32:47]
  ds_read_b128 v[72:75], v22 offset:32768
  ds_read_b128 v[96:99], v26 offset:16384
  ds_read_b128 v[100:103], v26 offset:20480
  v_mfma_f32_32x32x16_bf16 v[48:63], v[140:143], v[116:119], v[48:63]
  ds_read_b128 v[76:79], v23 offset:32768
  ds_read_b128 v[104:107], v27 offset:16384
  ds_read_b128 v[108:111], v27 offset:20480
  v_mfma_f32_32x32x16_bf16 v[32:47], v[144:147], v[120:123], v[32:47]
  v_mfma_f32_32x32x16_bf16 v[48:63], v[148:151], v[120:123], v[48:63]
  v_mfma_f32_32x32x16_bf16 v[32:47], v[152:155], v[124:127], v[32:47]
  v_mfma_f32_32x32x16_bf16 v[48:63], v[156:159], v[124:127], v[48:63]
  s_waitcnt lgkmcnt(0)
  s_barrier
  v_mfma_f32_32x32x16_bf16 v[32:47], v[80:83], v[64:67], v[32:47]
  ds_read_b128 v[112:115], v20 offset:49152
  ds_read_b128 v[128:131], v24 offset:24576
  ds_read_b128 v[132:135], v24 offset:28672
  v_mfma_f32_32x32x16_bf16 v[48:63], v[84:87], v[64:67], v[48:63]
  ds_read_b128 v[116:119], v21 offset:49152
  ds_read_b128 v[136:139], v25 offset:24576
  ds_read_b128 v[140:143], v25 offset:28672
  v_mfma_f32_32x32x16_bf16 v[32:47], v[88:91], v[68:71], v[32:47]
  ds_read_b128 v[120:123], v22 offset:49152
  ds_read_b128 v[144:147], v26 offset:24576
  ds_read_b128 v[148:151], v26 offset:28672
  v_mfma_f32_32x32x16_bf16 v[48:63], v[92:95], v[68:71], v[48:63]
  ds_read_b128 v[124:127], v23 offset:49152
  ds_read_b128 v[152:155], v27 offset:24576
  ds_read_b128 v[156:159], v27 offset:28672
  v_mfma_f32_32x32x16_bf16 v[32:47], v[96:99], v[72:75], v[32:47]
  v_mfma_f32_32x32x16_bf16 v[48:63], v[100:103], v[72:75], v[48:63]
  v_mfma_f32_32x32x16_bf16 v[32:47], v[104:107], v[76:79], v[32:47]
  v_mfma_f32_32x32x16_bf16 v[48:63], v[108:111], v[76:79], v[48:63]
  s_waitcnt lgkmcnt(0)
  s_barrier
  v_mfma_f32_32x32x16_bf16 v[32:47], v[128:131], v[112:115], v[32:47]
  ds_read_b128 v[64:67], v28 offset:0
  ds_read_b128 v[80:83], v24 offset:32768
  ds_read_b128 v[84:87], v24 offset:36864
  v_mfma_f32_32x32x16_bf16 v[48:63], v[132:135], v[112:115], v[48:63]
  ds_read_b128 v[68:71], v29 offset:0
  ds_read_b128 v[88:91], v25 offset:32768
  ds_read_b128 v[92:95], v25 offset:36864
  v_mfma_f32_32x32x16_bf16 v[32:47], v[136:139], v[116:119], v[32:47]
  ds_read_b128 v[72:75], v30 offset:0
  ds_read_b128 v[96:99], v26 offset:32768
  ds_read_b128 v[100:103], v26 offset:36864
  v_mfma_f32_32x32x16_bf16 v[48:63], v[140:143], v[116:119], v[48:63]
  ds_read_b128 v[76:79], v31 offset:0
  ds_read_b128 v[104:107], v27 offset:32768
  ds_read_b128 v[108:111], v27 offset:36864
  v_mfma_f32_32x32x16_bf16 v[32:47], v[144:147], v[120:123], v[32:47]
  v_mfma_f32_32x32x16_bf16 v[48:63], v[148:151], v[120:123], v[48:63]
  v_mfma_f32_32x32x16_bf16 v[32:47], v[152:155], v[124:127], v[32:47]
  v_mfma_f32_32x32x16_bf16 v[48:63], v[156:159], v[124:127], v[48:63]
  s_waitcnt lgkmcnt(0)
  s_barrier
  v_mfma_f32_32x32x16_bf16 v[32:47], v[80:83], v[64:67], v[32:47]
  ds_read_b128 v[112:115], v28 offset:16384
  ds_read_b128 v[128:131], v24 offset:40960
  ds_read_b128 v[132:135], v24 offset:45056
  v_mfma_f32_32x32x16_bf16 v[48:63], v[84:87], v[64:67], v[48:63]
  ds_read_b128 v[116:119], v29 offset:16384
  ds_read_b128 v[136:139], v25 offset:40960
  ds_read_b128 v[140:143], v25 offset:45056
  v_mfma_f32_32x32x16_bf16 v[32:47], v[88:91], v[68:71], v[32:47]
  ds_read_b128 v[120:123], v30 offset:16384
  ds_read_b128 v[144:147], v26 offset:40960
  ds_read_b128 v[148:151], v26 offset:45056
  v_mfma_f32_32x32x16_bf16 v[48:63], v[92:95], v[68:71], v[48:63]
  ds_read_b128 v[124:127], v31 offset:16384
  ds_read_b128 v[152:155], v27 offset:40960
  ds_read_b128 v[156:159], v27 offset:45056
  v_mfma_f32_32x32x16_bf16 v[32:47], v[96:99], v[72:75], v[32:47]
  v_mfma_f32_32x32x16_bf16 v[48:63], v[100:103], v[72:75], v[48:63]
  v_mfma_f32_32x32x16_bf16 v[32:47], v[104:107], v[76:79], v[32:47]
  v_mfma_f32_32x32x16_bf16 v[48:63], v[108:111], v[76:79], v[48:63]
  s_waitcnt lgkmcnt(0)
  s_barrier
  v_mfma_f32_32x32x16_bf16 v[32:47], v[128:131], v[112:115], v[32:47]
  ds_read_b128 v[64:67], v20 offset:0
  ds_read_b128 v[80:83], v24 offset:0
  ds_read_b128 v[84:87], v24 offset:4096
  v_mfma_f32_32x32x16_bf16 v[48:63], v[132:135], v[112:115], v[48:63]
  ds_read_b128 v[68:71], v21 offset:0
  ds_read_b128 v[88:91], v25 offset:0
  ds_read_b128 v[92:95], v25 offset:4096
  v_mfma_f32_32x32x16_bf16 v[32:47], v[136:139], v[116:119], v[32:47]
  ds_read_b128 v[72:75], v22 offset:0
  ds_read_b128 v[96:99], v26 offset:0
  ds_read_b128 v[100:103], v26 offset:4096
  v_mfma_f32_32x32x16_bf16 v[48:63], v[140:143], v[116:119], v[48:63]
  ds_read_b128 v[76:79], v23 offset:0
  ds_read_b128 v[104:107], v27 offset:0
  ds_read_b128 v[108:111], v27 offset:4096
  v_mfma_f32_32x32x16_bf16 v[32:47], v[144:147], v[120:123], v[32:47]
  v_mfma_f32_32x32x16_bf16 v[48:63], v[148:151], v[120:123], v[48:63]
  v_mfma_f32_32x32x16_bf16 v[32:47], v[152:155], v[124:127], v[32:47]
  v_mfma_f32_32x32x16_bf16 v[48:63], v[156:159], v[124:127], v[48:63]
  s_waitcnt lgkmcnt(0)
  s_barrier
  v_mfma_f32_32x32x16_bf16 v[32:47], v[80:83], v[64:67], v[32:47]
  ds_read_b128 v[112:115], v20 offset:16384
  ds_read_b128 v[128:131], v24 offset:8192
  ds_read_b128 v[132:135], v24 offset:12288
  v_mfma_f32_32x32x16_bf16 v[48:63], v[84:87], v[64:67], v[48:63]
  ds_read_b128 v[116:119], v21 offset:16384
  ds_read_b128 v[136:139], v25 offset:8192
  ds_read_b128 v[140:143], v25 offset:12288
  v_mfma_f32_32x32x16_bf16 v[32:47], v[88:91], v[68:71], v[32:47]
  ds_read_b128 v[120:123], v22 offset:16384
  ds_read_b128 v[144:147], v26 offset:8192
  ds_read_b128 v[148:151], v26 offset:12288
  v_mfma_f32_32x32x16_bf16 v[48:63], v[92:95], v[68:71], v[48:63]
  ds_read_b128 v[124:127], v23 offset:16384
  ds_read_b128 v[152:155], v27 offset:8192
  ds_read_b128 v[156:159], v27 offset:12288
  v_mfma_f32_32x32x16_bf16 v[32:47], v[96:99], v[72:75], v[32:47]
  v_mfma_f32_32x32x16_bf16 v[48:63], v[100:103], v[72:75], v[48:63]
  v_mfma_f32_32x32x16_bf16 v[32:47], v[104:107], v[76:79], v[32:47]
  v_mfma_f32_32x32x16_bf16 v[48:63], v[108:111], v[76:79], v[48:63]
  s_waitcnt lgkmcnt(0)
  s_barrier
  v_mfma_f32_32x32x16_bf16 v[32:47], v[128:131], v[112:115], v[32:47]
  ds_read_b128 v[64:67], v20 offset:32768
  ds_read_b128 v[80:83], v24 offset:16384
  ds_read_b128 v[84:87], v24 offset:20480
  v_mfma_f32_32x32x16_bf16 v[48:63], v[132:135], v[112:115], v[48:63]
  ds_read_b128 v[68:71], v21 offset:32768
  ds_read_b128 v[88:91], v25 offset:16384
  ds_read_b128 v[92:95], v25 offset:20480
  v_mfma_f32_32x32x16_bf16 v[32:47], v[136:139], v[116:119], v[32:47]
  ds_read_b128 v[72:75], v22 offset:32768
  ds_read_b128 v[96:99], v26 offset:16384
  ds_read_b128 v[100:103], v26 offset:20480
  v_mfma_f32_32x32x16_bf16 v[48:63], v[140:143], v[116:119], v[48:63]
  ds_read_b128 v[76:79], v23 offset:32768
  ds_read_b128 v[104:107], v27 offset:16384
  ds_read_b128 v[108:111], v27 offset:20480
  v_mfma_f32_32x32x16_bf16 v[32:47], v[144:147], v[120:123], v[32:47]
  v_mfma_f32_32x32x16_bf16 v[48:63], v[148:151], v[120:123], v[48:63]
  v_mfma_f32_32x32x16_bf16 v[32:47], v[152:155], v[124:127], v[32:47]
  v_mfma_f32_32x32x16_bf16 v[48:63], v[156:159], v[124:127], v[48:63]
  s_waitcnt lgkmcnt(0)
  s_barrier
  v_mfma_f32_32x32x16_bf16 v[32:47], v[80:83], v[64:67], v[32:47]
  ds_read_b128 v[112:115], v20 offset:49152
  ds_read_b128 v[128:131], v24 offset:24576
  ds_read_b128 v[132:135], v24 offset:28672
  v_mfma_f32_32x32x16_bf16 v[48:63], v[84:87], v[64:67], v[48:63]
  ds_read_b128 v[116:119], v21 offset:49152
  ds_read_b128 v[136:139], v25 offset:24576
  ds_read_b128 v[140:143], v25 offset:28672
  v_mfma_f32_32x32x16_bf16 v[32:47], v[88:91], v[68:71], v[32:47]
  ds_read_b128 v[120:123], v22 offset:49152
  ds_read_b128 v[144:147], v26 offset:24576
  ds_read_b128 v[148:151], v26 offset:28672
  v_mfma_f32_32x32x16_bf16 v[48:63], v[92:95], v[68:71], v[48:63]
  ds_read_b128 v[124:127], v23 offset:49152
  ds_read_b128 v[152:155], v27 offset:24576
  ds_read_b128 v[156:159], v27 offset:28672
  v_mfma_f32_32x32x16_bf16 v[32:47], v[96:99], v[72:75], v[32:47]
  v_mfma_f32_32x32x16_bf16 v[48:63], v[100:103], v[72:75], v[48:63]
  v_mfma_f32_32x32x16_bf16 v[32:47], v[104:107], v[76:79], v[32:47]
  v_mfma_f32_32x32x16_bf16 v[48:63], v[108:111], v[76:79], v[48:63]
  s_waitcnt lgkmcnt(0)
  s_barrier
  v_mfma_f32_32x32x16_bf16 v[32:47], v[128:131], v[112:115], v[32:47]
  ds_read_b128 v[64:67], v28 offset:0
  ds_read_b128 v[80:83], v24 offset:32768
  ds_read_b128 v[84:87], v24 offset:36864
  v_mfma_f32_32x32x16_bf16 v[48:63], v[132:135], v[112:115], v[48:63]
  ds_read_b128 v[68:71], v29 offset:0
  ds_read_b128 v[88:91], v25 offset:32768
  ds_read_b128 v[92:95], v25 offset:36864
  v_mfma_f32_32x32x16_bf16 v[32:47], v[136:139], v[116:119], v[32:47]
  ds_read_b128 v[72:75], v30 offset:0
  ds_read_b128 v[96:99], v26 offset:32768
  ds_read_b128 v[100:103], v26 offset:36864
  v_mfma_f32_32x32x16_bf16 v[48:63], v[140:143], v[116:119], v[48:63]
  ds_read_b128 v[76:79], v31 offset:0
  ds_read_b128 v[104:107], v27 offset:32768
  ds_read_b128 v[108:111], v27 offset:36864
  v_mfma_f32_32x32x16_bf16 v[32:47], v[144:147], v[120:123], v[32:47]
  v_mfma_f32_32x32x16_bf16 v[48:63], v[148:151], v[120:123], v[48:63]
  v_mfma_f32_32x32x16_bf16 v[32:47], v[152:155], v[124:127], v[32:47]
  v_mfma_f32_32x32x16_bf16 v[48:63], v[156:159], v[124:127], v[48:63]
  s_waitcnt lgkmcnt(0)
  s_barrier
  v_mfma_f32_32x32x16_bf16 v[32:47], v[80:83], v[64:67], v[32:47]
  ds_read_b128 v[112:115], v28 offset:16384
  ds_read_b128 v[128:131], v24 offset:40960
  ds_read_b128 v[132:135], v24 offset:45056
  v_mfma_f32_32x32x16_bf16 v[48:63], v[84:87], v[64:67], v[48:63]
  ds_read_b128 v[116:119], v29 offset:16384
  ds_read_b128 v[136:139], v25 offset:40960
  ds_read_b128 v[140:143], v25 offset:45056
  v_mfma_f32_32x32x16_bf16 v[32:47], v[88:91], v[68:71], v[32:47]
  ds_read_b128 v[120:123], v30 offset:16384
  ds_read_b128 v[144:147], v26 offset:40960
  ds_read_b128 v[148:151], v26 offset:45056
  v_mfma_f32_32x32x16_bf16 v[48:63], v[92:95], v[68:71], v[48:63]
  ds_read_b128 v[124:127], v31 offset:16384
  ds_read_b128 v[152:155], v27 offset:40960
  ds_read_b128 v[156:159], v27 offset:45056
  v_mfma_f32_32x32x16_bf16 v[32:47], v[96:99], v[72:75], v[32:47]
  v_mfma_f32_32x32x16_bf16 v[48:63], v[100:103], v[72:75], v[48:63]
  v_mfma_f32_32x32x16_bf16 v[32:47], v[104:107], v[76:79], v[32:47]
  v_mfma_f32_32x32x16_bf16 v[48:63], v[108:111], v[76:79], v[48:63]
  s_waitcnt lgkmcnt(0)
  s_barrier
  v_mfma_f32_32x32x16_bf16 v[32:47], v[128:131], v[112:115], v[32:47]
  ds_read_b128 v[64:67], v20 offset:0
  ds_read_b128 v[80:83], v24 offset:0
  ds_read_b128 v[84:87], v24 offset:4096
  v_mfma_f32_32x32x16_bf16 v[48:63], v[132:135], v[112:115], v[48:63]
  ds_read_b128 v[68:71], v21 offset:0
  ds_read_b128 v[88:91], v25 offset:0
  ds_read_b128 v[92:95], v25 offset:4096
  v_mfma_f32_32x32x16_bf16 v[32:47], v[136:139], v[116:119], v[32:47]
  ds_read_b128 v[72:75], v22 offset:0
  ds_read_b128 v[96:99], v26 offset:0
  ds_read_b128 v[100:103], v26 offset:4096
  v_mfma_f32_32x32x16_bf16 v[48:63], v[140:143], v[116:119], v[48:63]
  ds_read_b128 v[76:79], v23 offset:0
  ds_read_b128 v[104:107], v27 offset:0
  ds_read_b128 v[108:111], v27 offset:4096
  v_mfma_f32_32x32x16_bf16 v[32:47], v[144:147], v[120:123], v[32:47]
  v_mfma_f32_32x32x16_bf16 v[48:63], v[148:151], v[120:123], v[48:63]
  v_mfma_f32_32x32x16_bf16 v[32:47], v[152:155], v[124:127], v[32:47]
  v_mfma_f32_32x32x16_bf16 v[48:63], v[156:159], v[124:127], v[48:63]
  s_waitcnt lgkmcnt(0)
  s_barrier
  v_mfma_f32_32x32x16_bf16 v[32:47], v[80:83], v[64:67], v[32:47]
  ds_read_b128 v[112:115], v20 offset:16384
  ds_read_b128 v[128:131], v24 offset:8192
  ds_read_b128 v[132:135], v24 offset:12288
  v_mfma_f32_32x32x16_bf16 v[48:63], v[84:87], v[64:67], v[48:63]
  ds_read_b128 v[116:119], v21 offset:16384
  ds_read_b128 v[136:139], v25 offset:8192
  ds_read_b128 v[140:143], v25 offset:12288
  v_mfma_f32_32x32x16_bf16 v[32:47], v[88:91], v[68:71], v[32:47]
  ds_read_b128 v[120:123], v22 offset:16384
  ds_read_b128 v[144:147], v26 offset:8192
  ds_read_b128 v[148:151], v26 offset:12288
  v_mfma_f32_32x32x16_bf16 v[48:63], v[92:95], v[68:71], v[48:63]
  ds_read_b128 v[124:127], v23 offset:16384
  ds_read_b128 v[152:155], v27 offset:8192
  ds_read_b128 v[156:159], v27 offset:12288
  v_mfma_f32_32x32x16_bf16 v[32:47], v[96:99], v[72:75], v[32:47]
  v_mfma_f32_32x32x16_bf16 v[48:63], v[100:103], v[72:75], v[48:63]
  v_mfma_f32_32x32x16_bf16 v[32:47], v[104:107], v[76:79], v[32:47]
  v_mfma_f32_32x32x16_bf16 v[48:63], v[108:111], v[76:79], v[48:63]
  s_waitcnt lgkmcnt(0)
  s_barrier
  v_mfma_f32_32x32x16_bf16 v[32:47], v[128:131], v[112:115], v[32:47]
  ds_read_b128 v[64:67], v20 offset:32768
  ds_read_b128 v[80:83], v24 offset:16384
  ds_read_b128 v[84:87], v24 offset:20480
  v_mfma_f32_32x32x16_bf16 v[48:63], v[132:135], v[112:115], v[48:63]
  ds_read_b128 v[68:71], v21 offset:32768
  ds_read_b128 v[88:91], v25 offset:16384
  ds_read_b128 v[92:95], v25 offset:20480
  v_mfma_f32_32x32x16_bf16 v[32:47], v[136:139], v[116:119], v[32:47]
  ds_read_b128 v[72:75], v22 offset:32768
  ds_read_b128 v[96:99], v26 offset:16384
  ds_read_b128 v[100:103], v26 offset:20480
  v_mfma_f32_32x32x16_bf16 v[48:63], v[140:143], v[116:119], v[48:63]
  ds_read_b128 v[76:79], v23 offset:32768
  ds_read_b128 v[104:107], v27 offset:16384
  ds_read_b128 v[108:111], v27 offset:20480
  v_mfma_f32_32x32x16_bf16 v[32:47], v[144:147], v[120:123], v[32:47]
  v_mfma_f32_32x32x16_bf16 v[48:63], v[148:151], v[120:123], v[48:63]
  v_mfma_f32_32x32x16_bf16 v[32:47], v[152:155], v[124:127], v[32:47]
  v_mfma_f32_32x32x16_bf16 v[48:63], v[156:159], v[124:127], v[48:63]
  s_waitcnt lgkmcnt(0)
  s_barrier
  v_mfma_f32_32x32x16_bf16 v[32:47], v[80:83], v[64:67], v[32:47]
  ds_read_b128 v[112:115], v20 offset:49152
  ds_read_b128 v[128:131], v24 offset:24576
  ds_read_b128 v[132:135], v24 offset:28672
  v_mfma_f32_32x32x16_bf16 v[48:63], v[84:87], v[64:67], v[48:63]
  ds_read_b128 v[116:119], v21 offset:49152
  ds_read_b128 v[136:139], v25 offset:24576
  ds_read_b128 v[140:143], v25 offset:28672
  v_mfma_f32_32x32x16_bf16 v[32:47], v[88:91], v[68:71], v[32:47]
  ds_read_b128 v[120:123], v22 offset:49152
  ds_read_b128 v[144:147], v26 offset:24576
  ds_read_b128 v[148:151], v26 offset:28672
  v_mfma_f32_32x32x16_bf16 v[48:63], v[92:95], v[68:71], v[48:63]
  ds_read_b128 v[124:127], v23 offset:49152
  ds_read_b128 v[152:155], v27 offset:24576
  ds_read_b128 v[156:159], v27 offset:28672
  v_mfma_f32_32x32x16_bf16 v[32:47], v[96:99], v[72:75], v[32:47]
  v_mfma_f32_32x32x16_bf16 v[48:63], v[100:103], v[72:75], v[48:63]
  v_mfma_f32_32x32x16_bf16 v[32:47], v[104:107], v[76:79], v[32:47]
  v_mfma_f32_32x32x16_bf16 v[48:63], v[108:111], v[76:79], v[48:63]
  s_waitcnt lgkmcnt(0)
  s_barrier
  v_mfma_f32_32x32x16_bf16 v[32:47], v[128:131], v[112:115], v[32:47]
  ds_read_b128 v[64:67], v28 offset:0
  ds_read_b128 v[80:83], v24 offset:32768
  ds_read_b128 v[84:87], v24 offset:36864
  v_mfma_f32_32x32x16_bf16 v[48:63], v[132:135], v[112:115], v[48:63]
  ds_read_b128 v[68:71], v29 offset:0
  ds_read_b128 v[88:91], v25 offset:32768
  ds_read_b128 v[92:95], v25 offset:36864
  v_mfma_f32_32x32x16_bf16 v[32:47], v[136:139], v[116:119], v[32:47]
  ds_read_b128 v[72:75], v30 offset:0
  ds_read_b128 v[96:99], v26 offset:32768
  ds_read_b128 v[100:103], v26 offset:36864
  v_mfma_f32_32x32x16_bf16 v[48:63], v[140:143], v[116:119], v[48:63]
  ds_read_b128 v[76:79], v31 offset:0
  ds_read_b128 v[104:107], v27 offset:32768
  ds_read_b128 v[108:111], v27 offset:36864
  v_mfma_f32_32x32x16_bf16 v[32:47], v[144:147], v[120:123], v[32:47]
  v_mfma_f32_32x32x16_bf16 v[48:63], v[148:151], v[120:123], v[48:63]
  v_mfma_f32_32x32x16_bf16 v[32:47], v[152:155], v[124:127], v[32:47]
  v_mfma_f32_32x32x16_bf16 v[48:63], v[156:159], v[124:127], v[48:63]
  s_waitcnt lgkmcnt(0)
  s_barrier
  v_mfma_f32_32x32x16_bf16 v[32:47], v[80:83], v[64:67], v[32:47]
  ds_read_b128 v[112:115], v28 offset:16384
  ds_read_b128 v[128:131], v24 offset:40960
  ds_read_b128 v[132:135], v24 offset:45056
  v_mfma_f32_32x32x16_bf16 v[48:63], v[84:87], v[64:67], v[48:63]
  ds_read_b128 v[116:119], v29 offset:16384
  ds_read_b128 v[136:139], v25 offset:40960
  ds_read_b128 v[140:143], v25 offset:45056
  v_mfma_f32_32x32x16_bf16 v[32:47], v[88:91], v[68:71], v[32:47]
  ds_read_b128 v[120:123], v30 offset:16384
  ds_read_b128 v[144:147], v26 offset:40960
  ds_read_b128 v[148:151], v26 offset:45056
  v_mfma_f32_32x32x16_bf16 v[48:63], v[92:95], v[68:71], v[48:63]
  ds_read_b128 v[124:127], v31 offset:16384
  ds_read_b128 v[152:155], v27 offset:40960
  ds_read_b128 v[156:159], v27 offset:45056
  v_mfma_f32_32x32x16_bf16 v[32:47], v[96:99], v[72:75], v[32:47]
  v_mfma_f32_32x32x16_bf16 v[48:63], v[100:103], v[72:75], v[48:63]
  v_mfma_f32_32x32x16_bf16 v[32:47], v[104:107], v[76:79], v[32:47]
  v_mfma_f32_32x32x16_bf16 v[48:63], v[108:111], v[76:79], v[48:63]
  s_waitcnt lgkmcnt(0)
  s_barrier
  v_mfma_f32_32x32x16_bf16 v[32:47], v[128:131], v[112:115], v[32:47]
  ds_read_b128 v[64:67], v20 offset:0
  ds_read_b128 v[80:83], v24 offset:0
  ds_read_b128 v[84:87], v24 offset:4096
  v_mfma_f32_32x32x16_bf16 v[48:63], v[132:135], v[112:115], v[48:63]
  ds_read_b128 v[68:71], v21 offset:0
  ds_read_b128 v[88:91], v25 offset:0
  ds_read_b128 v[92:95], v25 offset:4096
  v_mfma_f32_32x32x16_bf16 v[32:47], v[136:139], v[116:119], v[32:47]
  ds_read_b128 v[72:75], v22 offset:0
  ds_read_b128 v[96:99], v26 offset:0
  ds_read_b128 v[100:103], v26 offset:4096
  v_mfma_f32_32x32x16_bf16 v[48:63], v[140:143], v[116:119], v[48:63]
  ds_read_b128 v[76:79], v23 offset:0
  ds_read_b128 v[104:107], v27 offset:0
  ds_read_b128 v[108:111], v27 offset:4096
  v_mfma_f32_32x32x16_bf16 v[32:47], v[144:147], v[120:123], v[32:47]
  v_mfma_f32_32x32x16_bf16 v[48:63], v[148:151], v[120:123], v[48:63]
  v_mfma_f32_32x32x16_bf16 v[32:47], v[152:155], v[124:127], v[32:47]
  v_mfma_f32_32x32x16_bf16 v[48:63], v[156:159], v[124:127], v[48:63]
  s_waitcnt lgkmcnt(0)
  s_barrier
  v_mfma_f32_32x32x16_bf16 v[32:47], v[80:83], v[64:67], v[32:47]
  ds_read_b128 v[112:115], v20 offset:16384
  ds_read_b128 v[128:131], v24 offset:8192
  ds_read_b128 v[132:135], v24 offset:12288
  v_mfma_f32_32x32x16_bf16 v[48:63], v[84:87], v[64:67], v[48:63]
  ds_read_b128 v[116:119], v21 offset:16384
  ds_read_b128 v[136:139], v25 offset:8192
  ds_read_b128 v[140:143], v25 offset:12288
  v_mfma_f32_32x32x16_bf16 v[32:47], v[88:91], v[68:71], v[32:47]
  ds_read_b128 v[120:123], v22 offset:16384
  ds_read_b128 v[144:147], v26 offset:8192
  ds_read_b128 v[148:151], v26 offset:12288
  v_mfma_f32_32x32x16_bf16 v[48:63], v[92:95], v[68:71], v[48:63]
  ds_read_b128 v[124:127], v23 offset:16384
  ds_read_b128 v[152:155], v27 offset:8192
  ds_read_b128 v[156:159], v27 offset:12288
  v_mfma_f32_32x32x16_bf16 v[32:47], v[96:99], v[72:75], v[32:47]
  v_mfma_f32_32x32x16_bf16 v[48:63], v[100:103], v[72:75], v[48:63]
  v_mfma_f32_32x32x16_bf16 v[32:47], v[104:107], v[76:79], v[32:47]
  v_mfma_f32_32x32x16_bf16 v[48:63], v[108:111], v[76:79], v[48:63]
  s_waitcnt lgkmcnt(0)
  s_barrier
  v_mfma_f32_32x32x16_bf16 v[32:47], v[128:131], v[112:115], v[32:47]
  ds_read_b128 v[64:67], v20 offset:32768
  ds_read_b128 v[80:83], v24 offset:16384
  ds_read_b128 v[84:87], v24 offset:20480
  v_mfma_f32_32x32x16_bf16 v[48:63], v[132:135], v[112:115], v[48:63]
  ds_read_b128 v[68:71], v21 offset:32768
  ds_read_b128 v[88:91], v25 offset:16384
  ds_read_b128 v[92:95], v25 offset:20480
  v_mfma_f32_32x32x16_bf16 v[32:47], v[136:139], v[116:119], v[32:47]
  ds_read_b128 v[72:75], v22 offset:32768
  ds_read_b128 v[96:99], v26 offset:16384
  ds_read_b128 v[100:103], v26 offset:20480
  v_mfma_f32_32x32x16_bf16 v[48:63], v[140:143], v[116:119], v[48:63]
  ds_read_b128 v[76:79], v23 offset:32768
  ds_read_b128 v[104:107], v27 offset:16384
  ds_read_b128 v[108:111], v27 offset:20480
  v_mfma_f32_32x32x16_bf16 v[32:47], v[144:147], v[120:123], v[32:47]
  v_mfma_f32_32x32x16_bf16 v[48:63], v[148:151], v[120:123], v[48:63]
  v_mfma_f32_32x32x16_bf16 v[32:47], v[152:155], v[124:127], v[32:47]
  v_mfma_f32_32x32x16_bf16 v[48:63], v[156:159], v[124:127], v[48:63]
  s_waitcnt lgkmcnt(0)
  s_barrier
  v_mfma_f32_32x32x16_bf16 v[32:47], v[80:83], v[64:67], v[32:47]
  ds_read_b128 v[112:115], v20 offset:49152
  ds_read_b128 v[128:131], v24 offset:24576
  ds_read_b128 v[132:135], v24 offset:28672
  v_mfma_f32_32x32x16_bf16 v[48:63], v[84:87], v[64:67], v[48:63]
  ds_read_b128 v[116:119], v21 offset:49152
  ds_read_b128 v[136:139], v25 offset:24576
  ds_read_b128 v[140:143], v25 offset:28672
  v_mfma_f32_32x32x16_bf16 v[32:47], v[88:91], v[68:71], v[32:47]
  ds_read_b128 v[120:123], v22 offset:49152
  ds_read_b128 v[144:147], v26 offset:24576
  ds_read_b128 v[148:151], v26 offset:28672
  v_mfma_f32_32x32x16_bf16 v[48:63], v[92:95], v[68:71], v[48:63]
  ds_read_b128 v[124:127], v23 offset:49152
  ds_read_b128 v[152:155], v27 offset:24576
  ds_read_b128 v[156:159], v27 offset:28672
  v_mfma_f32_32x32x16_bf16 v[32:47], v[96:99], v[72:75], v[32:47]
  v_mfma_f32_32x32x16_bf16 v[48:63], v[100:103], v[72:75], v[48:63]
  v_mfma_f32_32x32x16_bf16 v[32:47], v[104:107], v[76:79], v[32:47]
  v_mfma_f32_32x32x16_bf16 v[48:63], v[108:111], v[76:79], v[48:63]
  s_waitcnt lgkmcnt(0)
  s_barrier
  v_mfma_f32_32x32x16_bf16 v[32:47], v[128:131], v[112:115], v[32:47]
  ds_read_b128 v[64:67], v28 offset:0
  ds_read_b128 v[80:83], v24 offset:32768
  ds_read_b128 v[84:87], v24 offset:36864
  v_mfma_f32_32x32x16_bf16 v[48:63], v[132:135], v[112:115], v[48:63]
  ds_read_b128 v[68:71], v29 offset:0
  ds_read_b128 v[88:91], v25 offset:32768
  ds_read_b128 v[92:95], v25 offset:36864
  v_mfma_f32_32x32x16_bf16 v[32:47], v[136:139], v[116:119], v[32:47]
  ds_read_b128 v[72:75], v30 offset:0
  ds_read_b128 v[96:99], v26 offset:32768
  ds_read_b128 v[100:103], v26 offset:36864
  v_mfma_f32_32x32x16_bf16 v[48:63], v[140:143], v[116:119], v[48:63]
  ds_read_b128 v[76:79], v31 offset:0
  ds_read_b128 v[104:107], v27 offset:32768
  ds_read_b128 v[108:111], v27 offset:36864
  v_mfma_f32_32x32x16_bf16 v[32:47], v[144:147], v[120:123], v[32:47]
  v_mfma_f32_32x32x16_bf16 v[48:63], v[148:151], v[120:123], v[48:63]
  v_mfma_f32_32x32x16_bf16 v[32:47], v[152:155], v[124:127], v[32:47]
  v_mfma_f32_32x32x16_bf16 v[48:63], v[156:159], v[124:127], v[48:63]
  s_waitcnt lgkmcnt(0)
  s_barrier
  v_mfma_f32_32x32x16_bf16 v[32:47], v[80:83], v[64:67], v[32:47]
  ds_read_b128 v[112:115], v28 offset:16384
  ds_read_b128 v[128:131], v24 offset:40960
  ds_read_b128 v[132:135], v24 offset:45056
  v_mfma_f32_32x32x16_bf16 v[48:63], v[84:87], v[64:67], v[48:63]
  ds_read_b128 v[116:119], v29 offset:16384
  ds_read_b128 v[136:139], v25 offset:40960
  ds_read_b128 v[140:143], v25 offset:45056
  v_mfma_f32_32x32x16_bf16 v[32:47], v[88:91], v[68:71], v[32:47]
  ds_read_b128 v[120:123], v30 offset:16384
  ds_read_b128 v[144:147], v26 offset:40960
  ds_read_b128 v[148:151], v26 offset:45056
  v_mfma_f32_32x32x16_bf16 v[48:63], v[92:95], v[68:71], v[48:63]
  ds_read_b128 v[124:127], v31 offset:16384
  ds_read_b128 v[152:155], v27 offset:40960
  ds_read_b128 v[156:159], v27 offset:45056
  v_mfma_f32_32x32x16_bf16 v[32:47], v[96:99], v[72:75], v[32:47]
  v_mfma_f32_32x32x16_bf16 v[48:63], v[100:103], v[72:75], v[48:63]
  v_mfma_f32_32x32x16_bf16 v[32:47], v[104:107], v[76:79], v[32:47]
  v_mfma_f32_32x32x16_bf16 v[48:63], v[108:111], v[76:79], v[48:63]
  s_waitcnt lgkmcnt(0)
  s_barrier
  v_mfma_f32_32x32x16_bf16 v[32:47], v[128:131], v[112:115], v[32:47]
  ds_read_b128 v[64:67], v20 offset:0
  ds_read_b128 v[80:83], v24 offset:0
  ds_read_b128 v[84:87], v24 offset:4096
  v_mfma_f32_32x32x16_bf16 v[48:63], v[132:135], v[112:115], v[48:63]
  ds_read_b128 v[68:71], v21 offset:0
  ds_read_b128 v[88:91], v25 offset:0
  ds_read_b128 v[92:95], v25 offset:4096
  v_mfma_f32_32x32x16_bf16 v[32:47], v[136:139], v[116:119], v[32:47]
  ds_read_b128 v[72:75], v22 offset:0
  ds_read_b128 v[96:99], v26 offset:0
  ds_read_b128 v[100:103], v26 offset:4096
  v_mfma_f32_32x32x16_bf16 v[48:63], v[140:143], v[116:119], v[48:63]
  ds_read_b128 v[76:79], v23 offset:0
  ds_read_b128 v[104:107], v27 offset:0
  ds_read_b128 v[108:111], v27 offset:4096
  v_mfma_f32_32x32x16_bf16 v[32:47], v[144:147], v[120:123], v[32:47]
  v_mfma_f32_32x32x16_bf16 v[48:63], v[148:151], v[120:123], v[48:63]
  v_mfma_f32_32x32x16_bf16 v[32:47], v[152:155], v[124:127], v[32:47]
  v_mfma_f32_32x32x16_bf16 v[48:63], v[156:159], v[124:127], v[48:63]
  s_waitcnt lgkmcnt(0)
  s_barrier
  v_mfma_f32_32x32x16_bf16 v[32:47], v[80:83], v[64:67], v[32:47]
  ds_read_b128 v[112:115], v20 offset:16384
  ds_read_b128 v[128:131], v24 offset:8192
  ds_read_b128 v[132:135], v24 offset:12288
  v_mfma_f32_32x32x16_bf16 v[48:63], v[84:87], v[64:67], v[48:63]
  ds_read_b128 v[116:119], v21 offset:16384
  ds_read_b128 v[136:139], v25 offset:8192
  ds_read_b128 v[140:143], v25 offset:12288
  v_mfma_f32_32x32x16_bf16 v[32:47], v[88:91], v[68:71], v[32:47]
  ds_read_b128 v[120:123], v22 offset:16384
  ds_read_b128 v[144:147], v26 offset:8192
  ds_read_b128 v[148:151], v26 offset:12288
  v_mfma_f32_32x32x16_bf16 v[48:63], v[92:95], v[68:71], v[48:63]
  ds_read_b128 v[124:127], v23 offset:16384
  ds_read_b128 v[152:155], v27 offset:8192
  ds_read_b128 v[156:159], v27 offset:12288
  v_mfma_f32_32x32x16_bf16 v[32:47], v[96:99], v[72:75], v[32:47]
  v_mfma_f32_32x32x16_bf16 v[48:63], v[100:103], v[72:75], v[48:63]
  v_mfma_f32_32x32x16_bf16 v[32:47], v[104:107], v[76:79], v[32:47]
  v_mfma_f32_32x32x16_bf16 v[48:63], v[108:111], v[76:79], v[48:63]
  s_waitcnt lgkmcnt(0)
  s_barrier
  v_mfma_f32_32x32x16_bf16 v[32:47], v[128:131], v[112:115], v[32:47]
  ds_read_b128 v[64:67], v20 offset:32768
  ds_read_b128 v[80:83], v24 offset:16384
  ds_read_b128 v[84:87], v24 offset:20480
  v_mfma_f32_32x32x16_bf16 v[48:63], v[132:135], v[112:115], v[48:63]
  ds_read_b128 v[68:71], v21 offset:32768
  ds_read_b128 v[88:91], v25 offset:16384
  ds_read_b128 v[92:95], v25 offset:20480
  v_mfma_f32_32x32x16_bf16 v[32:47], v[136:139], v[116:119], v[32:47]
  ds_read_b128 v[72:75], v22 offset:32768
  ds_read_b128 v[96:99], v26 offset:16384
  ds_read_b128 v[100:103], v26 offset:20480
  v_mfma_f32_32x32x16_bf16 v[48:63], v[140:143], v[116:119], v[48:63]
  ds_read_b128 v[76:79], v23 offset:32768
  ds_read_b128 v[104:107], v27 offset:16384
  ds_read_b128 v[108:111], v27 offset:20480
  v_mfma_f32_32x32x16_bf16 v[32:47], v[144:147], v[120:123], v[32:47]
  v_mfma_f32_32x32x16_bf16 v[48:63], v[148:151], v[120:123], v[48:63]
  v_mfma_f32_32x32x16_bf16 v[32:47], v[152:155], v[124:127], v[32:47]
  v_mfma_f32_32x32x16_bf16 v[48:63], v[156:159], v[124:127], v[48:63]
  s_waitcnt lgkmcnt(0)
  s_barrier
  v_mfma_f32_32x32x16_bf16 v[32:47], v[80:83], v[64:67], v[32:47]
  ds_read_b128 v[112:115], v20 offset:49152
  ds_read_b128 v[128:131], v24 offset:24576
  ds_read_b128 v[132:135], v24 offset:28672
  v_mfma_f32_32x32x16_bf16 v[48:63], v[84:87], v[64:67], v[48:63]
  ds_read_b128 v[116:119], v21 offset:49152
  ds_read_b128 v[136:139], v25 offset:24576
  ds_read_b128 v[140:143], v25 offset:28672
  v_mfma_f32_32x32x16_bf16 v[32:47], v[88:91], v[68:71], v[32:47]
  ds_read_b128 v[120:123], v22 offset:49152
  ds_read_b128 v[144:147], v26 offset:24576
  ds_read_b128 v[148:151], v26 offset:28672
  v_mfma_f32_32x32x16_bf16 v[48:63], v[92:95], v[68:71], v[48:63]
  ds_read_b128 v[124:127], v23 offset:49152
  ds_read_b128 v[152:155], v27 offset:24576
  ds_read_b128 v[156:159], v27 offset:28672
  v_mfma_f32_32x32x16_bf16 v[32:47], v[96:99], v[72:75], v[32:47]
  v_mfma_f32_32x32x16_bf16 v[48:63], v[100:103], v[72:75], v[48:63]
  v_mfma_f32_32x32x16_bf16 v[32:47], v[104:107], v[76:79], v[32:47]
  v_mfma_f32_32x32x16_bf16 v[48:63], v[108:111], v[76:79], v[48:63]
  s_waitcnt lgkmcnt(0)
  s_barrier
  v_mfma_f32_32x32x16_bf16 v[32:47], v[128:131], v[112:115], v[32:47]
  ds_read_b128 v[64:67], v28 offset:0
  ds_read_b128 v[80:83], v24 offset:32768
  ds_read_b128 v[84:87], v24 offset:36864
  v_mfma_f32_32x32x16_bf16 v[48:63], v[132:135], v[112:115], v[48:63]
  ds_read_b128 v[68:71], v29 offset:0
  ds_read_b128 v[88:91], v25 offset:32768
  ds_read_b128 v[92:95], v25 offset:36864
  v_mfma_f32_32x32x16_bf16 v[32:47], v[136:139], v[116:119], v[32:47]
  ds_read_b128 v[72:75], v30 offset:0
  ds_read_b128 v[96:99], v26 offset:32768
  ds_read_b128 v[100:103], v26 offset:36864
  v_mfma_f32_32x32x16_bf16 v[48:63], v[140:143], v[116:119], v[48:63]
  ds_read_b128 v[76:79], v31 offset:0
  ds_read_b128 v[104:107], v27 offset:32768
  ds_read_b128 v[108:111], v27 offset:36864
  v_mfma_f32_32x32x16_bf16 v[32:47], v[144:147], v[120:123], v[32:47]
  v_mfma_f32_32x32x16_bf16 v[48:63], v[148:151], v[120:123], v[48:63]
  v_mfma_f32_32x32x16_bf16 v[32:47], v[152:155], v[124:127], v[32:47]
  v_mfma_f32_32x32x16_bf16 v[48:63], v[156:159], v[124:127], v[48:63]
  s_waitcnt lgkmcnt(0)
  s_barrier
  v_mfma_f32_32x32x16_bf16 v[32:47], v[80:83], v[64:67], v[32:47]
  ds_read_b128 v[112:115], v28 offset:16384
  ds_read_b128 v[128:131], v24 offset:40960
  ds_read_b128 v[132:135], v24 offset:45056
  v_mfma_f32_32x32x16_bf16 v[48:63], v[84:87], v[64:67], v[48:63]
  ds_read_b128 v[116:119], v29 offset:16384
  ds_read_b128 v[136:139], v25 offset:40960
  ds_read_b128 v[140:143], v25 offset:45056
  v_mfma_f32_32x32x16_bf16 v[32:47], v[88:91], v[68:71], v[32:47]
  ds_read_b128 v[120:123], v30 offset:16384
  ds_read_b128 v[144:147], v26 offset:40960
  ds_read_b128 v[148:151], v26 offset:45056
  v_mfma_f32_32x32x16_bf16 v[48:63], v[92:95], v[68:71], v[48:63]
  ds_read_b128 v[124:127], v31 offset:16384
  ds_read_b128 v[152:155], v27 offset:40960
  ds_read_b128 v[156:159], v27 offset:45056
  v_mfma_f32_32x32x16_bf16 v[32:47], v[96:99], v[72:75], v[32:47]
  v_mfma_f32_32x32x16_bf16 v[48:63], v[100:103], v[72:75], v[48:63]
  v_mfma_f32_32x32x16_bf16 v[32:47], v[104:107], v[76:79], v[32:47]
  v_mfma_f32_32x32x16_bf16 v[48:63], v[108:111], v[76:79], v[48:63]
  s_waitcnt lgkmcnt(0)
  s_barrier
  v_mfma_f32_32x32x16_bf16 v[32:47], v[128:131], v[112:115], v[32:47]
  ds_read_b128 v[64:67], v20 offset:0
  ds_read_b128 v[80:83], v24 offset:0
  ds_read_b128 v[84:87], v24 offset:4096
  v_mfma_f32_32x32x16_bf16 v[48:63], v[132:135], v[112:115], v[48:63]
  ds_read_b128 v[68:71], v21 offset:0
  ds_read_b128 v[88:91], v25 offset:0
  ds_read_b128 v[92:95], v25 offset:4096
  v_mfma_f32_32x32x16_bf16 v[32:47], v[136:139], v[116:119], v[32:47]
  ds_read_b128 v[72:75], v22 offset:0
  ds_read_b128 v[96:99], v26 offset:0
  ds_read_b128 v[100:103], v26 offset:4096
  v_mfma_f32_32x32x16_bf16 v[48:63], v[140:143], v[116:119], v[48:63]
  ds_read_b128 v[76:79], v23 offset:0
  ds_read_b128 v[104:107], v27 offset:0
  ds_read_b128 v[108:111], v27 offset:4096
  v_mfma_f32_32x32x16_bf16 v[32:47], v[144:147], v[120:123], v[32:47]
  v_mfma_f32_32x32x16_bf16 v[48:63], v[148:151], v[120:123], v[48:63]
  v_mfma_f32_32x32x16_bf16 v[32:47], v[152:155], v[124:127], v[32:47]
  v_mfma_f32_32x32x16_bf16 v[48:63], v[156:159], v[124:127], v[48:63]
  s_waitcnt lgkmcnt(0)
  s_barrier
  v_mfma_f32_32x32x16_bf16 v[32:47], v[80:83], v[64:67], v[32:47]
  ds_read_b128 v[112:115], v20 offset:16384
  ds_read_b128 v[128:131], v24 offset:8192
  ds_read_b128 v[132:135], v24 offset:12288
  v_mfma_f32_32x32x16_bf16 v[48:63], v[84:87], v[64:67], v[48:63]
  ds_read_b128 v[116:119], v21 offset:16384
  ds_read_b128 v[136:139], v25 offset:8192
  ds_read_b128 v[140:143], v25 offset:12288
  v_mfma_f32_32x32x16_bf16 v[32:47], v[88:91], v[68:71], v[32:47]
  ds_read_b128 v[120:123], v22 offset:16384
  ds_read_b128 v[144:147], v26 offset:8192
  ds_read_b128 v[148:151], v26 offset:12288
  v_mfma_f32_32x32x16_bf16 v[48:63], v[92:95], v[68:71], v[48:63]
  ds_read_b128 v[124:127], v23 offset:16384
  ds_read_b128 v[152:155], v27 offset:8192
  ds_read_b128 v[156:159], v27 offset:12288
  v_mfma_f32_32x32x16_bf16 v[32:47], v[96:99], v[72:75], v[32:47]
  v_mfma_f32_32x32x16_bf16 v[48:63], v[100:103], v[72:75], v[48:63]
  v_mfma_f32_32x32x16_bf16 v[32:47], v[104:107], v[76:79], v[32:47]
  v_mfma_f32_32x32x16_bf16 v[48:63], v[108:111], v[76:79], v[48:63]
  s_waitcnt lgkmcnt(0)
  v_mfma_f32_32x32x16_bf16 v[32:47], v[128:131], v[112:115], v[32:47]
  v_mfma_f32_32x32x16_bf16 v[48:63], v[132:135], v[112:115], v[48:63]
  v_mfma_f32_32x32x16_bf16 v[32:47], v[136:139], v[116:119], v[32:47]
  v_mfma_f32_32x32x16_bf16 v[48:63], v[140:143], v[116:119], v[48:63]
  v_mfma_f32_32x32x16_bf16 v[32:47], v[144:147], v[120:123], v[32:47]
  v_mfma_f32_32x32x16_bf16 v[48:63], v[148:151], v[120:123], v[48:63]
  v_mfma_f32_32x32x16_bf16 v[32:47], v[152:155], v[124:127], v[32:47]
  v_mfma_f32_32x32x16_bf16 v[48:63], v[156:159], v[124:127], v[48:63]
  s_nop 15
  v_cvt_pk_bf16_f32 v64, v32, v33
  v_cvt_pk_bf16_f32 v65, v34, v35
  v_cvt_pk_bf16_f32 v66, v36, v37
  v_cvt_pk_bf16_f32 v67, v38, v39
  v_cvt_pk_bf16_f32 v68, v40, v41
  v_cvt_pk_bf16_f32 v69, v42, v43
  v_cvt_pk_bf16_f32 v70, v44, v45
  v_cvt_pk_bf16_f32 v71, v46, v47
  v_cvt_pk_bf16_f32 v72, v48, v49
  v_cvt_pk_bf16_f32 v73, v50, v51
  v_cvt_pk_bf16_f32 v74, v52, v53
  v_cvt_pk_bf16_f32 v75, v54, v55
  v_cvt_pk_bf16_f32 v76, v56, v57
  v_cvt_pk_bf16_f32 v77, v58, v59
  v_cvt_pk_bf16_f32 v78, v60, v61
  v_cvt_pk_bf16_f32 v79, v62, v63
  s_mul_i32 s30, s15, 4608
  s_add_u32 s30, s30, 49152
  v_mul_u32_u24 v18, 144, v16
  v_lshl_add_u32 v18, v17, 3, v18
  v_add_u32 v18, s30, v18
  ds_write_b64 v18, v[64:65] offset:0
  ds_write_b64 v18, v[66:67] offset:16
  ds_write_b64 v18, v[68:69] offset:32
  ds_write_b64 v18, v[70:71] offset:48
  ds_write_b64 v18, v[72:73] offset:64
  ds_write_b64 v18, v[74:75] offset:80
  ds_write_b64 v18, v[76:77] offset:96
  ds_write_b64 v18, v[78:79] offset:112
  v_lshrrev_b32 v19, 3, v0
  v_and_b32 v22, 7, v0
  v_mul_u32_u24 v20, 144, v19
  v_lshl_add_u32 v20, v22, 4, v20
  v_add_u32 v20, s30, v20
  s_waitcnt lgkmcnt(0)
  ds_read_b128 v[80:83], v20 offset:0
  ds_read_b128 v[84:87], v20 offset:1152
  ds_read_b128 v[88:91], v20 offset:2304
  ds_read_b128 v[92:95], v20 offset:3456
  s_lshl_b32 s24, s14, 21
  s_add_u32 s24, s24, 4194304
  s_lshl_b32 s30, s13, 7
  s_add_u32 s24, s24, s30
  s_lshl_b32 s30, s12, 7
  s_lshl_b32 s31, s15, 5
  s_add_u32 s30, s30, s31
  v_add_u32 v21, s30, v19
  v_lshlrev_b32 v21, 10, v21
  v_lshl_add_u32 v21, v22, 4, v21
  s_waitcnt lgkmcnt(3)
  buffer_store_dwordx4 v[80:83], v21, s[20:23], s24 offen sc1
  v_add_u32 v21, 0x2000, v21
  s_waitcnt lgkmcnt(2)
  buffer_store_dwordx4 v[84:87], v21, s[20:23], s24 offen sc1
  v_add_u32 v21, 0x2000, v21
  s_waitcnt lgkmcnt(1)
  buffer_store_dwordx4 v[88:91], v21, s[20:23], s24 offen sc1
  v_add_u32 v21, 0x2000, v21
  s_waitcnt lgkmcnt(0)
  buffer_store_dwordx4 v[92:95], v21, s[20:23], s24 offen sc1
  s_waitcnt vmcnt(0)
  s_barrier
  s_load_dwordx2 s[4:5], s[0:1], 0
  s_load_dwordx8 s[56:63], s[0:1], 48
  s_load_dwordx2 s[64:65], s[0:1], 80
  s_mov_b32 s24, s6
  s_mov_b32 s25, s7
  s_mov_b32 s26, 12582912
  s_mov_b32 s27, 0x00020000
  s_lshl_b32 s48, s14, 3
  s_add_u32 s48, s48, s13
  s_cmp_lg_u32 s15, 0
  s_cbranch_scc1 k2_noflag
  s_lshl_b32 s49, s12, 6
  s_lshl_b32 s50, s48, 2
  s_add_u32 s49, s49, s50
  s_add_u32 s49, s49, 8585216
  v_mov_b32 v4, s68
  v_mov_b32 v5, 0
  s_mov_b64 s[50:51], exec
  s_mov_b64 exec, 1
  buffer_store_dword v4, v5, s[24:27], s49 offen sc1
  s_mov_b64 exec, s[50:51]
k2_noflag:
  s_waitcnt lgkmcnt(0)
  s_mov_b32 s20, s4
  s_mov_b32 s21, s5
  s_mov_b32 s22, 2097152
  s_mov_b32 s23, 0x00020000
  s_mov_b32 s28, s56
  s_mov_b32 s29, s57
  s_mov_b32 s30, 1024
  s_mov_b32 s31, 0x00020000
  s_mov_b32 s44, s64
  s_mov_b32 s45, s65
  s_mov_b32 s46, 2097152
  s_mov_b32 s47, 0x00020000
  v_lshrrev_b32 v1, 5, v0
  v_and_b32 v2, 31, v0
  s_lshl_b32 s52, s12, 7
  s_lshl_b32 s53, s48, 3
  s_add_u32 s52, s52, s53
  s_lshl_b32 s53, s15, 1
  s_add_u32 s52, s52, s53
  v_add_u32 v1, s52, v1
  v_lshlrev_b32 v3, 10, v1
  v_lshl_add_u32 v3, v2, 4, v3
  v_lshlrev_b32 v4, 4, v2
  buffer_load_dwordx4 v[48:51], v3, s[20:23], 0 offen offset:0
  buffer_load_dwordx4 v[64:67], v4, s[28:31], 0 offen offset:0
  buffer_load_dwordx4 v[52:55], v3, s[20:23], 0 offen offset:512
  buffer_load_dwordx4 v[68:71], v4, s[28:31], 0 offen offset:512
  v_and_b32 v7, 15, v0
  v_lshlrev_b32 v7, 2, v7
  s_lshl_b32 s49, s12, 6
  s_add_u32 s49, s49, 8585216
  s_mov_b32 s53, 0
k2_poll:
  buffer_load_dword v4, v7, s[24:27], s49 offen sc1
  s_waitcnt vmcnt(0)
  v_cmp_ne_u32 s[54:55], s68, v4
  s_nop 3
  s_cmp_eq_u64 s[54:55], 0
  s_cbranch_scc1 k2_poll_ok
  s_add_u32 s53, s53, 1
  s_cmp_gt_u32 s53, 4194304
  s_cbranch_scc1 k2_poll_ok
  s_branch k2_poll
k2_poll_ok:
  s_mov_b32 s52, 4194304
  s_mov_b32 s53, 6291456
  buffer_load_dwordx4 v[16:19], v3, s[24:27], s52 offen offset:0 sc1
  buffer_load_dwordx4 v[32:35], v3, s[24:27], s53 offen offset:0 sc1
  buffer_load_dwordx4 v[20:23], v3, s[24:27], s52 offen offset:512 sc1
  buffer_load_dwordx4 v[36:39], v3, s[24:27], s53 offen offset:512 sc1
  v_mov_b32 v14, 0
  v_mov_b32 v15, 0
  s_waitcnt vmcnt(2)
  v_lshlrev_b32 v112, 16, v16
  v_and_b32 v113, 0xffff0000, v16
  v_lshlrev_b32 v114, 16, v32
  v_and_b32 v115, 0xffff0000, v32
  v_pk_add_f32 v[112:113], v[112:113], v[114:115] neg_lo:[0,1] neg_hi:[0,1]
  v_cvt_pk_bf16_f32 v112, v112, v113
  v_and_b32 v113, 0xffff0000, v112
  v_lshlrev_b32 v112, 16, v112
  v_lshlrev_b32 v114, 16, v48
  v_and_b32 v115, 0xffff0000, v48
  v_pk_add_f32 v[112:113], v[112:113], v[114:115]
  v_cvt_pk_bf16_f32 v112, v112, v113
  v_lshlrev_b32 v80, 16, v112
  v_and_b32 v81, 0xffff0000, v112
  v_pk_add_f32 v[14:15], v[14:15], v[80:81]
  v_lshlrev_b32 v112, 16, v17
  v_and_b32 v113, 0xffff0000, v17
  v_lshlrev_b32 v114, 16, v33
  v_and_b32 v115, 0xffff0000, v33
  v_pk_add_f32 v[112:113], v[112:113], v[114:115] neg_lo:[0,1] neg_hi:[0,1]
  v_cvt_pk_bf16_f32 v112, v112, v113
  v_and_b32 v113, 0xffff0000, v112
  v_lshlrev_b32 v112, 16, v112
  v_lshlrev_b32 v114, 16, v49
  v_and_b32 v115, 0xffff0000, v49
  v_pk_add_f32 v[112:113], v[112:113], v[114:115]
  v_cvt_pk_bf16_f32 v112, v112, v113
  v_lshlrev_b32 v82, 16, v112
  v_and_b32 v83, 0xffff0000, v112
  v_pk_add_f32 v[14:15], v[14:15], v[82:83]
  v_lshlrev_b32 v112, 16, v18
  v_and_b32 v113, 0xffff0000, v18
  v_lshlrev_b32 v114, 16, v34
  v_and_b32 v115, 0xffff0000, v34
  v_pk_add_f32 v[112:113], v[112:113], v[114:115] neg_lo:[0,1] neg_hi:[0,1]
  v_cvt_pk_bf16_f32 v112, v112, v113
  v_and_b32 v113, 0xffff0000, v112
  v_lshlrev_b32 v112, 16, v112
  v_lshlrev_b32 v114, 16, v50
  v_and_b32 v115, 0xffff0000, v50
  v_pk_add_f32 v[112:113], v[112:113], v[114:115]
  v_cvt_pk_bf16_f32 v112, v112, v113
  v_lshlrev_b32 v84, 16, v112
  v_and_b32 v85, 0xffff0000, v112
  v_pk_add_f32 v[14:15], v[14:15], v[84:85]
  v_lshlrev_b32 v112, 16, v19
  v_and_b32 v113, 0xffff0000, v19
  v_lshlrev_b32 v114, 16, v35
  v_and_b32 v115, 0xffff0000, v35
  v_pk_add_f32 v[112:113], v[112:113], v[114:115] neg_lo:[0,1] neg_hi:[0,1]
  v_cvt_pk_bf16_f32 v112, v112, v113
  v_and_b32 v113, 0xffff0000, v112
  v_lshlrev_b32 v112, 16, v112
  v_lshlrev_b32 v114, 16, v51
  v_and_b32 v115, 0xffff0000, v51
  v_pk_add_f32 v[112:113], v[112:113], v[114:115]
  v_cvt_pk_bf16_f32 v112, v112, v113
  v_lshlrev_b32 v86, 16, v112
  v_and_b32 v87, 0xffff0000, v112
  v_pk_add_f32 v[14:15], v[14:15], v[86:87]
  s_waitcnt vmcnt(0)
  v_lshlrev_b32 v112, 16, v20
  v_and_b32 v113, 0xffff0000, v20
  v_lshlrev_b32 v114, 16, v36
  v_and_b32 v115, 0xffff0000, v36
  v_pk_add_f32 v[112:113], v[112:113], v[114:115] neg_lo:[0,1] neg_hi:[0,1]
  v_cvt_pk_bf16_f32 v112, v112, v113
  v_and_b32 v113, 0xffff0000, v112
  v_lshlrev_b32 v112, 16, v112
  v_lshlrev_b32 v114, 16, v52
  v_and_b32 v115, 0xffff0000, v52
  v_pk_add_f32 v[112:113], v[112:113], v[114:115]
  v_cvt_pk_bf16_f32 v112, v112, v113
  v_lshlrev_b32 v88, 16, v112
  v_and_b32 v89, 0xffff0000, v112
  v_pk_add_f32 v[14:15], v[14:15], v[88:89]
  v_lshlrev_b32 v112, 16, v21
  v_and_b32 v113, 0xffff0000, v21
  v_lshlrev_b32 v114, 16, v37
  v_and_b32 v115, 0xffff0000, v37
  v_pk_add_f32 v[112:113], v[112:113], v[114:115] neg_lo:[0,1] neg_hi:[0,1]
  v_cvt_pk_bf16_f32 v112, v112, v113
  v_and_b32 v113, 0xffff0000, v112
  v_lshlrev_b32 v112, 16, v112
  v_lshlrev_b32 v114, 16, v53
  v_and_b32 v115, 0xffff0000, v53
  v_pk_add_f32 v[112:113], v[112:113], v[114:115]
  v_cvt_pk_bf16_f32 v112, v112, v113
  v_lshlrev_b32 v90, 16, v112
  v_and_b32 v91, 0xffff0000, v112
  v_pk_add_f32 v[14:15], v[14:15], v[90:91]
  v_lshlrev_b32 v112, 16, v22
  v_and_b32 v113, 0xffff0000, v22
  v_lshlrev_b32 v114, 16, v38
  v_and_b32 v115, 0xffff0000, v38
  v_pk_add_f32 v[112:113], v[112:113], v[114:115] neg_lo:[0,1] neg_hi:[0,1]
  v_cvt_pk_bf16_f32 v112, v112, v113
  v_and_b32 v113, 0xffff0000, v112
  v_lshlrev_b32 v112, 16, v112
  v_lshlrev_b32 v114, 16, v54
  v_and_b32 v115, 0xffff0000, v54
  v_pk_add_f32 v[112:113], v[112:113], v[114:115]
  v_cvt_pk_bf16_f32 v112, v112, v113
  v_lshlrev_b32 v92, 16, v112
  v_and_b32 v93, 0xffff0000, v112
  v_pk_add_f32 v[14:15], v[14:15], v[92:93]
  v_lshlrev_b32 v112, 16, v23
  v_and_b32 v113, 0xffff0000, v23
  v_lshlrev_b32 v114, 16, v39
  v_and_b32 v115, 0xffff0000, v39
  v_pk_add_f32 v[112:113], v[112:113], v[114:115] neg_lo:[0,1] neg_hi:[0,1]
  v_cvt_pk_bf16_f32 v112, v112, v113
  v_and_b32 v113, 0xffff0000, v112
  v_lshlrev_b32 v112, 16, v112
  v_lshlrev_b32 v114, 16, v55
  v_and_b32 v115, 0xffff0000, v55
  v_pk_add_f32 v[112:113], v[112:113], v[114:115]
  v_cvt_pk_bf16_f32 v112, v112, v113
  v_lshlrev_b32 v94, 16, v112
  v_and_b32 v95, 0xffff0000, v112
  v_pk_add_f32 v[14:15], v[14:15], v[94:95]
  v_add_f32 v5, v14, v15
  s_nop 1
  v_add_f32_dpp v5, v5, v5 quad_perm:[1,0,3,2] row_mask:0xf bank_mask:0xf
  s_nop 1
  v_add_f32_dpp v5, v5, v5 quad_perm:[2,3,0,1] row_mask:0xf bank_mask:0xf
  s_nop 1
  v_add_f32_dpp v5, v5, v5 row_half_mirror row_mask:0xf bank_mask:0xf
  s_nop 1
  v_add_f32_dpp v5, v5, v5 row_mirror row_mask:0xf bank_mask:0xf
  s_nop 1
  ds_swizzle_b32 v13, v5 offset:0x401F
  s_waitcnt lgkmcnt(0)
  v_add_f32 v5, v5, v13
  v_mul_f32 v5, 0x3b000000, v5
  v_cvt_pk_bf16_f32 v6, v5, v5
  v_lshlrev_b32 v6, 16, v6
  v_sub_f32 v8, 0, v6
  v_mov_b32 v9, v8
  v_mov_b32 v10, 0
  v_mov_b32 v11, 0
  v_pk_add_f32 v[116:117], v[80:81], v[8:9]
  v_pk_fma_f32 v[10:11], v[116:117], v[116:117], v[10:11]
  v_pk_add_f32 v[118:119], v[82:83], v[8:9]
  v_pk_fma_f32 v[10:11], v[118:119], v[118:119], v[10:11]
  v_pk_add_f32 v[120:121], v[84:85], v[8:9]
  v_pk_fma_f32 v[10:11], v[120:121], v[120:121], v[10:11]
  v_pk_add_f32 v[122:123], v[86:87], v[8:9]
  v_pk_fma_f32 v[10:11], v[122:123], v[122:123], v[10:11]
  v_pk_add_f32 v[124:125], v[88:89], v[8:9]
  v_pk_fma_f32 v[10:11], v[124:125], v[124:125], v[10:11]
  v_pk_add_f32 v[126:127], v[90:91], v[8:9]
  v_pk_fma_f32 v[10:11], v[126:127], v[126:127], v[10:11]
  v_pk_add_f32 v[128:129], v[92:93], v[8:9]
  v_pk_fma_f32 v[10:11], v[128:129], v[128:129], v[10:11]
  v_pk_add_f32 v[130:131], v[94:95], v[8:9]
  v_pk_fma_f32 v[10:11], v[130:131], v[130:131], v[10:11]
  v_add_f32 v10, v10, v11
  s_nop 1
  v_add_f32_dpp v10, v10, v10 quad_perm:[1,0,3,2] row_mask:0xf bank_mask:0xf
  s_nop 1
  v_add_f32_dpp v10, v10, v10 quad_perm:[2,3,0,1] row_mask:0xf bank_mask:0xf
  s_nop 1
  v_add_f32_dpp v10, v10, v10 row_half_mirror row_mask:0xf bank_mask:0xf
  s_nop 1
  v_add_f32_dpp v10, v10, v10 row_mirror row_mask:0xf bank_mask:0xf
  s_nop 1
  ds_swizzle_b32 v13, v10 offset:0x401F
  s_waitcnt lgkmcnt(0)
  v_add_f32 v10, v10, v13
  v_sub_f32 v11, v5, v6
  v_mul_f32 v11, v11, v11
  v_mul_f32 v10, 0x3b000000, v10
  v_sub_f32 v10, v10, v11
  v_max_f32 v10, 0, v10
  v_cvt_pk_bf16_f32 v10, v10, v10
  v_lshlrev_b32 v10, 16, v10
  v_add_f32 v10, 0x3727c5ac, v10
  v_cvt_pk_bf16_f32 v10, v10, v10
  v_lshlrev_b32 v10, 16, v10
  v_sqrt_f32 v10, v10
  s_nop 0
  v_cvt_pk_bf16_f32 v10, v10, v10
  v_lshlrev_b32 v10, 16, v10
  v_rcp_f32 v10, v10
  s_nop 0
  v_mov_b32 v11, v10
  v_mov_b32 v12, 0
  v_cvt_pk_bf16_f32 v112, v116, v117
  v_lshlrev_b32 v116, 16, v112
  v_and_b32 v117, 0xffff0000, v112
  v_pk_mul_f32 v[116:117], v[116:117], v[10:11]
  v_cvt_pk_bf16_f32 v112, v116, v117
  v_dot2_f32_bf16 v12, v112, v64, v12
  v_lshlrev_b32 v116, 16, v112
  v_and_b32 v117, 0xffff0000, v112
  v_pk_add_f32 v[116:117], v[116:117], v[80:81]
  v_cvt_pk_bf16_f32 v48, v116, v117
  v_cvt_pk_bf16_f32 v112, v118, v119
  v_lshlrev_b32 v118, 16, v112
  v_and_b32 v119, 0xffff0000, v112
  v_pk_mul_f32 v[118:119], v[118:119], v[10:11]
  v_cvt_pk_bf16_f32 v112, v118, v119
  v_dot2_f32_bf16 v12, v112, v65, v12
  v_lshlrev_b32 v118, 16, v112
  v_and_b32 v119, 0xffff0000, v112
  v_pk_add_f32 v[118:119], v[118:119], v[82:83]
  v_cvt_pk_bf16_f32 v49, v118, v119
  v_cvt_pk_bf16_f32 v112, v120, v121
  v_lshlrev_b32 v120, 16, v112
  v_and_b32 v121, 0xffff0000, v112
  v_pk_mul_f32 v[120:121], v[120:121], v[10:11]
  v_cvt_pk_bf16_f32 v112, v120, v121
  v_dot2_f32_bf16 v12, v112, v66, v12
  v_lshlrev_b32 v120, 16, v112
  v_and_b32 v121, 0xffff0000, v112
  v_pk_add_f32 v[120:121], v[120:121], v[84:85]
  v_cvt_pk_bf16_f32 v50, v120, v121
  v_cvt_pk_bf16_f32 v112, v122, v123
  v_lshlrev_b32 v122, 16, v112
  v_and_b32 v123, 0xffff0000, v112
  v_pk_mul_f32 v[122:123], v[122:123], v[10:11]
  v_cvt_pk_bf16_f32 v112, v122, v123
  v_dot2_f32_bf16 v12, v112, v67, v12
  v_lshlrev_b32 v122, 16, v112
  v_and_b32 v123, 0xffff0000, v112
  v_pk_add_f32 v[122:123], v[122:123], v[86:87]
  v_cvt_pk_bf16_f32 v51, v122, v123
  v_cvt_pk_bf16_f32 v112, v124, v125
  v_lshlrev_b32 v124, 16, v112
  v_and_b32 v125, 0xffff0000, v112
  v_pk_mul_f32 v[124:125], v[124:125], v[10:11]
  v_cvt_pk_bf16_f32 v112, v124, v125
  v_dot2_f32_bf16 v12, v112, v68, v12
  v_lshlrev_b32 v124, 16, v112
  v_and_b32 v125, 0xffff0000, v112
  v_pk_add_f32 v[124:125], v[124:125], v[88:89]
  v_cvt_pk_bf16_f32 v52, v124, v125
  v_cvt_pk_bf16_f32 v112, v126, v127
  v_lshlrev_b32 v126, 16, v112
  v_and_b32 v127, 0xffff0000, v112
  v_pk_mul_f32 v[126:127], v[126:127], v[10:11]
  v_cvt_pk_bf16_f32 v112, v126, v127
  v_dot2_f32_bf16 v12, v112, v69, v12
  v_lshlrev_b32 v126, 16, v112
  v_and_b32 v127, 0xffff0000, v112
  v_pk_add_f32 v[126:127], v[126:127], v[90:91]
  v_cvt_pk_bf16_f32 v53, v126, v127
  v_cvt_pk_bf16_f32 v112, v128, v129
  v_lshlrev_b32 v128, 16, v112
  v_and_b32 v129, 0xffff0000, v112
  v_pk_mul_f32 v[128:129], v[128:129], v[10:11]
  v_cvt_pk_bf16_f32 v112, v128, v129
  v_dot2_f32_bf16 v12, v112, v70, v12
  v_lshlrev_b32 v128, 16, v112
  v_and_b32 v129, 0xffff0000, v112
  v_pk_add_f32 v[128:129], v[128:129], v[92:93]
  v_cvt_pk_bf16_f32 v54, v128, v129
  v_cvt_pk_bf16_f32 v112, v130, v131
  v_lshlrev_b32 v130, 16, v112
  v_and_b32 v131, 0xffff0000, v112
  v_pk_mul_f32 v[130:131], v[130:131], v[10:11]
  v_cvt_pk_bf16_f32 v112, v130, v131
  v_dot2_f32_bf16 v12, v112, v71, v12
  v_lshlrev_b32 v130, 16, v112
  v_and_b32 v131, 0xffff0000, v112
  v_pk_add_f32 v[130:131], v[130:131], v[94:95]
  v_cvt_pk_bf16_f32 v55, v130, v131
  buffer_store_dwordx4 v[48:51], v3, s[44:47], 0 offen offset:0
  buffer_store_dwordx4 v[52:55], v3, s[44:47], 0 offen offset:512
  s_nop 3
  s_nop 1
  v_add_f32_dpp v12, v12, v12 quad_perm:[1,0,3,2] row_mask:0xf bank_mask:0xf
  s_nop 1
  v_add_f32_dpp v12, v12, v12 quad_perm:[2,3,0,1] row_mask:0xf bank_mask:0xf
  s_nop 1
  v_add_f32_dpp v12, v12, v12 row_half_mirror row_mask:0xf bank_mask:0xf
  s_nop 1
  v_add_f32_dpp v12, v12, v12 row_mirror row_mask:0xf bank_mask:0xf
  s_nop 1
  ds_swizzle_b32 v13, v12 offset:0x401F
  s_waitcnt lgkmcnt(0)
  v_add_f32 v12, v12, v13
  v_cvt_pk_bf16_f32 v12, v12, v12
  v_lshlrev_b32 v12, 16, v12
  v_ashrrev_i32 v13, 31, v12
  v_or_b32 v13, 0x80000000, v13
  v_xor_b32 v12, v12, v13
  v_and_b32 v12, 0xffff0000, v12
  v_sub_u32 v13, 0xffff, v1
  v_or_b32 v12, v12, v13
  v_lshlrev_b32 v13, 2, v1
  v_lshlrev_b32 v14, 3, v1
  v_mov_b32 v7, v10
  v_cmp_eq_u32 vcc, 0, v2
  s_and_saveexec_b64 s[50:51], vcc
  s_mov_b32 s52, 8388608
  buffer_store_dword v12, v13, s[24:27], s52 offen
  s_mov_b32 s52, 8396800
  buffer_store_dwordx2 v[6:7], v14, s[24:27], s52 offen
  s_mov_b64 exec, s[50:51]
  s_cmp_ge_u32 s15, 2
  s_cbranch_scc1 k2_done
  s_cmp_eq_u32 s15, 0
  s_cselect_b32 s40, s58, s60
  s_cselect_b32 s41, s59, s61
  s_mov_b32 s42, 1835008
  s_mov_b32 s43, 0x00020000
  s_and_b32 s52, s2, 7
  s_lshr_b32 s53, s2, 3
  v_min_u32 v1, 55, v0
  v_cmp_lt_u32 vcc, 27, v1
  s_nop 1
  v_cndmask_b32 v2, 0, 1, vcc
  v_mul_u32_u24 v3, 28, v2
  v_sub_u32 v3, v1, v3
  v_mul_u32_u24 v2, 3584, v2
  v_lshl_add_u32 v2, v3, 4, v2
  s_mul_i32 s54, s52, 448
  s_mul_i32 s55, s53, 57344
  s_add_u32 s54, s54, s55
  buffer_load_dwordx4 v[80:83], v2, s[40:43], s54 offen
  s_add_u32 s54, s54, 7168
  buffer_load_dwordx4 v[84:87], v2, s[40:43], s54 offen
  s_add_u32 s54, s54, 7168
  buffer_load_dwordx4 v[88:91], v2, s[40:43], s54 offen
  s_add_u32 s54, s54, 7168
  buffer_load_dwordx4 v[92:95], v2, s[40:43], s54 offen
  s_add_u32 s54, s54, 7168
  buffer_load_dwordx4 v[96:99], v2, s[40:43], s54 offen
  s_add_u32 s54, s54, 7168
  buffer_load_dwordx4 v[100:103], v2, s[40:43], s54 offen
  s_add_u32 s54, s54, 7168
  buffer_load_dwordx4 v[104:107], v2, s[40:43], s54 offen
  s_add_u32 s54, s54, 7168
  buffer_load_dwordx4 v[108:111], v2, s[40:43], s54 offen
  s_add_u32 s54, s54, 7168
k2_done:
  s_endpgm
.globl t4_kernel
.p2align 8
.type t4_kernel,@function
t4_kernel:
  s_cmp_ge_u32 s2, 240
  s_cbranch_scc1 t4_done
  s_load_dwordx2 s[4:5], s[0:1], 0
  s_load_dwordx2 s[6:7], s[0:1], 96
  s_load_dwordx4 s[8:11], s[0:1], 56
  s_load_dwordx2 s[44:45], s[0:1], 80
  s_and_b32 s3, s2, 7
  s_mul_i32 s3, s3, 28
  s_lshr_b32 s12, s2, 3
  s_add_u32 s3, s3, s12
  v_mov_b32 v40, v0
  v_lshrrev_b32 v1, 6, v0
  v_and_b32 v0, 63, v0
  v_readfirstlane_b32 s13, v1
  s_waitcnt lgkmcnt(0)
  s_mov_b32 s16, s4
  s_mov_b32 s17, s5
  s_mov_b32 s18, 2097152
  s_mov_b32 s19, 0x00020000
  s_mov_b32 s20, s6
  s_mov_b32 s21, s7
  s_mov_b32 s22, 12582912
  s_mov_b32 s23, 0x00020000
  s_mov_b32 s24, s8
  s_mov_b32 s25, s9
  s_mov_b32 s26, 1835008
  s_mov_b32 s27, 0x00020000
  s_mov_b32 s28, s10
  s_mov_b32 s29, s11
  s_mov_b32 s30, 1835008
  s_mov_b32 s31, 0x00020000
  s_mov_b32 s48, s44
  s_mov_b32 s49, s45
  s_mov_b32 s50, 2097152
  s_mov_b32 s51, 0x00020000
  v_lshlrev_b32 v2, 5, v40
  s_mov_b32 s14, 8388608
  buffer_load_dwordx4 v[8:11], v2, s[20:23], s14 offen
  buffer_load_dwordx4 v[12:15], v2, s[20:23], s14 offen offset:16
  s_cmp_ge_u32 s2, 224
  s_cbranch_scc1 t4_dma2
  s_lshl_b32 s15, s3, 4
  s_movk_i32 s32, 3584
  s_lshl_b32 s33, s13, 7
  s_add_u32 s33, s33, 0
  v_add_u32 v3, s33, v0
  v_mul_lo_u32 v3, v3, s32
  s_lshl_b32 s34, s13, 11
  s_add_u32 m0, s34, 8704
  s_nop 0
  buffer_load_dwordx4 v3, s[24:27], s15 offen lds
  s_add_u32 m0, s34, 16896
  s_nop 0
  buffer_load_dwordx4 v3, s[28:31], s15 offen lds
  s_lshl_b32 s33, s13, 7
  s_add_u32 s33, s33, 64
  v_add_u32 v3, s33, v0
  v_mul_lo_u32 v3, v3, s32
  s_lshl_b32 s34, s13, 11
  s_add_u32 m0, s34, 9728
  s_nop 0
  buffer_load_dwordx4 v3, s[24:27], s15 offen lds
  s_add_u32 m0, s34, 17920
  s_nop 0
  buffer_load_dwordx4 v3, s[28:31], s15 offen lds
  s_waitcnt vmcnt(4)
  s_branch t4_top
t4_dma2:
  s_sub_u32 s46, s2, 224
  v_lshlrev_b32 v3, 4, v0
  s_mul_i32 s34, s13, 7168
  s_mul_i32 s33, s46, 114688
  s_add_u32 s33, s33, s34
  s_add_u32 s33, s33, 10485760
  s_add_u32 m0, s34, 8704
  s_nop 0
  buffer_load_dwordx4 v3, s[20:23], s33 offen lds
  s_add_u32 s33, s33, 1024
  s_add_u32 m0, s34, 9728
  s_nop 0
  buffer_load_dwordx4 v3, s[20:23], s33 offen lds
  s_add_u32 s33, s33, 1024
  s_add_u32 m0, s34, 10752
  s_nop 0
  buffer_load_dwordx4 v3, s[20:23], s33 offen lds
  s_add_u32 s33, s33, 1024
  s_add_u32 m0, s34, 11776
  s_nop 0
  buffer_load_dwordx4 v3, s[20:23], s33 offen lds
  s_add_u32 s33, s33, 1024
  s_add_u32 m0, s34, 12800
  s_nop 0
  buffer_load_dwordx4 v3, s[20:23], s33 offen lds
  s_add_u32 s33, s33, 1024
  s_add_u32 m0, s34, 13824
  s_nop 0
  buffer_load_dwordx4 v3, s[20:23], s33 offen lds
  s_add_u32 s33, s33, 1024
  s_add_u32 m0, s34, 14848
  s_nop 0
  buffer_load_dwordx4 v3, s[20:23], s33 offen lds
  s_add_u32 s33, s33, 22528
  s_add_u32 m0, s34, 37376
  s_nop 0
  buffer_load_dwordx4 v3, s[20:23], s33 offen lds
  s_add_u32 s33, s33, 1024
  s_add_u32 m0, s34, 38400
  s_nop 0
  buffer_load_dwordx4 v3, s[20:23], s33 offen lds
  s_add_u32 s33, s33, 1024
  s_add_u32 m0, s34, 39424
  s_nop 0
  buffer_load_dwordx4 v3, s[20:23], s33 offen lds
  s_add_u32 s33, s33, 1024
  s_add_u32 m0, s34, 40448
  s_nop 0
  buffer_load_dwordx4 v3, s[20:23], s33 offen lds
  s_add_u32 s33, s33, 1024
  s_add_u32 m0, s34, 41472
  s_nop 0
  buffer_load_dwordx4 v3, s[20:23], s33 offen lds
  s_add_u32 s33, s33, 1024
  s_add_u32 m0, s34, 42496
  s_nop 0
  buffer_load_dwordx4 v3, s[20:23], s33 offen lds
  s_add_u32 s33, s33, 1024
  s_add_u32 m0, s34, 43520
  s_nop 0
  buffer_load_dwordx4 v3, s[20:23], s33 offen lds
  s_add_u32 s33, s33, 22528
  s_add_u32 m0, s34, 66048
  s_nop 0
  buffer_load_dwordx4 v3, s[20:23], s33 offen lds
  s_add_u32 s33, s33, 1024
  s_add_u32 m0, s34, 67072
  s_nop 0
  buffer_load_dwordx4 v3, s[20:23], s33 offen lds
  s_add_u32 s33, s33, 1024
  s_add_u32 m0, s34, 68096
  s_nop 0
  buffer_load_dwordx4 v3, s[20:23], s33 offen lds
  s_add_u32 s33, s33, 1024
  s_add_u32 m0, s34, 69120
  s_nop 0
  buffer_load_dwordx4 v3, s[20:23], s33 offen lds
  s_add_u32 s33, s33, 1024
  s_add_u32 m0, s34, 70144
  s_nop 0
  buffer_load_dwordx4 v3, s[20:23], s33 offen lds
  s_add_u32 s33, s33, 1024
  s_add_u32 m0, s34, 71168
  s_nop 0
  buffer_load_dwordx4 v3, s[20:23], s33 offen lds
  s_add_u32 s33, s33, 1024
  s_add_u32 m0, s34, 72192
  s_nop 0
  buffer_load_dwordx4 v3, s[20:23], s33 offen lds
  s_add_u32 s33, s33, 22528
  s_add_u32 m0, s34, 94720
  s_nop 0
  buffer_load_dwordx4 v3, s[20:23], s33 offen lds
  s_add_u32 s33, s33, 1024
  s_add_u32 m0, s34, 95744
  s_nop 0
  buffer_load_dwordx4 v3, s[20:23], s33 offen lds
  s_add_u32 s33, s33, 1024
  s_add_u32 m0, s34, 96768
  s_nop 0
  buffer_load_dwordx4 v3, s[20:23], s33 offen lds
  s_add_u32 s33, s33, 1024
  s_add_u32 m0, s34, 97792
  s_nop 0
  buffer_load_dwordx4 v3, s[20:23], s33 offen lds
  s_add_u32 s33, s33, 1024
  s_add_u32 m0, s34, 98816
  s_nop 0
  buffer_load_dwordx4 v3, s[20:23], s33 offen lds
  s_add_u32 s33, s33, 1024
  s_add_u32 m0, s34, 99840
  s_nop 0
  buffer_load_dwordx4 v3, s[20:23], s33 offen lds
  s_add_u32 s33, s33, 1024
  s_add_u32 m0, s34, 100864
  s_nop 0
  buffer_load_dwordx4 v3, s[20:23], s33 offen lds
  s_add_u32 s33, s33, 22528
  s_waitcnt vmcnt(28)
t4_top:
  v_max_u32 v23, v8, v9
  v_min_u32 v22, v8, v9
  v_max_u32 v9, v10, v11
  v_min_u32 v8, v10, v11
  v_max_u32 v11, v12, v13
  v_min_u32 v10, v12, v13
  v_max_u32 v13, v14, v15
  v_min_u32 v12, v14, v15
  v_max_u32 v15, v23, v9
  v_min_u32 v14, v23, v9
  v_max_u32 v9, v22, v8
  v_min_u32 v23, v22, v8
  v_max_u32 v8, v11, v13
  v_min_u32 v22, v11, v13
  v_max_u32 v13, v10, v12
  v_min_u32 v11, v10, v12
  v_max_u32 v12, v9, v14
  v_min_u32 v10, v9, v14
  v_max_u32 v14, v13, v22
  v_min_u32 v9, v13, v22
  v_max_u32 v22, v15, v8
  v_min_u32 v13, v15, v8
  v_max_u32 v8, v12, v14
  v_min_u32 v15, v12, v14
  v_max_u32 v14, v10, v9
  v_min_u32 v12, v10, v9
  v_max_u32 v9, v23, v11
  v_min_u32 v10, v23, v11
  v_max_u32 v11, v14, v13
  v_min_u32 v23, v14, v13
  v_max_u32 v13, v9, v15
  v_min_u32 v14, v9, v15
  v_max_u32 v15, v8, v11
  v_min_u32 v9, v8, v11
  v_max_u32 v11, v13, v23
  v_min_u32 v8, v13, v23
  v_max_u32 v23, v14, v12
  v_min_u32 v13, v14, v12
  v_mov_b32 v14, 0
  s_nop 0
  s_nop 0
  v_max_u32_dpp v12, v22, v22 quad_perm:[1,0,3,2] row_mask:0xf bank_mask:0xf
  s_nop 0
  s_nop 0
  v_max_u32_dpp v12, v12, v12 quad_perm:[2,3,0,1] row_mask:0xf bank_mask:0xf
  s_nop 0
  s_nop 0
  v_max_u32_dpp v12, v12, v12 row_half_mirror row_mask:0xf bank_mask:0xf
  s_nop 0
  s_nop 0
  v_max_u32_dpp v12, v12, v12 row_mirror row_mask:0xf bank_mask:0xf
  s_nop 0
  v_readlane_b32 s36, v12, 0
  v_readlane_b32 s37, v12, 16
  v_readlane_b32 s38, v12, 32
  v_readlane_b32 s39, v12, 48
  s_max_u32 s36, s36, s37
  s_max_u32 s38, s38, s39
  s_max_u32 s36, s36, s38
  v_writelane_b32 v14, s36, 0
  v_cmp_eq_u32 vcc, s36, v22
  s_nop 1
  v_cndmask_b32 v22, v22, v15, vcc
  v_cndmask_b32 v15, v15, v9, vcc
  v_cndmask_b32 v9, v9, v11, vcc
  v_max_u32_dpp v12, v22, v22 quad_perm:[1,0,3,2] row_mask:0xf bank_mask:0xf
  v_cndmask_b32 v11, v11, v8, vcc
  v_cndmask_b32 v8, v8, v23, vcc
  v_max_u32_dpp v12, v12, v12 quad_perm:[2,3,0,1] row_mask:0xf bank_mask:0xf
  v_cndmask_b32 v23, v23, v13, vcc
  v_cndmask_b32 v13, v13, v10, vcc
  v_max_u32_dpp v12, v12, v12 row_half_mirror row_mask:0xf bank_mask:0xf
  s_nop 0
  s_nop 0
  v_max_u32_dpp v12, v12, v12 row_mirror row_mask:0xf bank_mask:0xf
  s_nop 0
  v_readlane_b32 s36, v12, 0
  v_readlane_b32 s37, v12, 16
  v_readlane_b32 s38, v12, 32
  v_readlane_b32 s39, v12, 48
  s_max_u32 s36, s36, s37
  s_max_u32 s38, s38, s39
  s_max_u32 s36, s36, s38
  v_writelane_b32 v14, s36, 1
  v_cmp_eq_u32 vcc, s36, v22
  s_nop 1
  v_cndmask_b32 v22, v22, v15, vcc
  v_cndmask_b32 v15, v15, v9, vcc
  v_cndmask_b32 v9, v9, v11, vcc
  v_max_u32_dpp v12, v22, v22 quad_perm:[1,0,3,2] row_mask:0xf bank_mask:0xf
  v_cndmask_b32 v11, v11, v8, vcc
  v_cndmask_b32 v8, v8, v23, vcc
  v_max_u32_dpp v12, v12, v12 quad_perm:[2,3,0,1] row_mask:0xf bank_mask:0xf
  v_cndmask_b32 v23, v23, v13, vcc
  s_nop 0
  v_max_u32_dpp v12, v12, v12 row_half_mirror row_mask:0xf bank_mask:0xf
  s_nop 0
  s_nop 0
  v_max_u32_dpp v12, v12, v12 row_mirror row_mask:0xf bank_mask:0xf
  s_nop 0
  v_readlane_b32 s36, v12, 0
  v_readlane_b32 s37, v12, 16
  v_readlane_b32 s38, v12, 32
  v_readlane_b32 s39, v12, 48
  s_max_u32 s36, s36, s37
  s_max_u32 s38, s38, s39
  s_max_u32 s36, s36, s38
  v_writelane_b32 v14, s36, 2
  v_cmp_eq_u32 vcc, s36, v22
  s_nop 1
  v_cndmask_b32 v22, v22, v15, vcc
  v_cndmask_b32 v15, v15, v9, vcc
  v_cndmask_b32 v9, v9, v11, vcc
  v_max_u32_dpp v12, v22, v22 quad_perm:[1,0,3,2] row_mask:0xf bank_mask:0xf
  v_cndmask_b32 v11, v11, v8, vcc
  v_cndmask_b32 v8, v8, v23, vcc
  v_max_u32_dpp v12, v12, v12 quad_perm:[2,3,0,1] row_mask:0xf bank_mask:0xf
  s_nop 0
  s_nop 0
  v_max_u32_dpp v12, v12, v12 row_half_mirror row_mask:0xf bank_mask:0xf
  s_nop 0
  s_nop 0
  v_max_u32_dpp v12, v12, v12 row_mirror row_mask:0xf bank_mask:0xf
  s_nop 0
  v_readlane_b32 s36, v12, 0
  v_readlane_b32 s37, v12, 16
  v_readlane_b32 s38, v12, 32
  v_readlane_b32 s39, v12, 48
  s_max_u32 s36, s36, s37
  s_max_u32 s38, s38, s39
  s_max_u32 s36, s36, s38
  v_writelane_b32 v14, s36, 3
  v_cmp_eq_u32 vcc, s36, v22
  s_nop 1
  v_cndmask_b32 v22, v22, v15, vcc
  v_cndmask_b32 v15, v15, v9, vcc
  v_cndmask_b32 v9, v9, v11, vcc
  v_max_u32_dpp v12, v22, v22 quad_perm:[1,0,3,2] row_mask:0xf bank_mask:0xf
  v_cndmask_b32 v11, v11, v8, vcc
  s_nop 0
  v_max_u32_dpp v12, v12, v12 quad_perm:[2,3,0,1] row_mask:0xf bank_mask:0xf
  s_nop 0
  s_nop 0
  v_max_u32_dpp v12, v12, v12 row_half_mirror row_mask:0xf bank_mask:0xf
  s_nop 0
  s_nop 0
  v_max_u32_dpp v12, v12, v12 row_mirror row_mask:0xf bank_mask:0xf
  s_nop 0
  v_readlane_b32 s36, v12, 0
  v_readlane_b32 s37, v12, 16
  v_readlane_b32 s38, v12, 32
  v_readlane_b32 s39, v12, 48
  s_max_u32 s36, s36, s37
  s_max_u32 s38, s38, s39
  s_max_u32 s36, s36, s38
  v_writelane_b32 v14, s36, 4
  v_cmp_eq_u32 vcc, s36, v22
  s_nop 1
  v_cndmask_b32 v22, v22, v15, vcc
  v_cndmask_b32 v15, v15, v9, vcc
  v_cndmask_b32 v9, v9, v11, vcc
  v_max_u32_dpp v12, v22, v22 quad_perm:[1,0,3,2] row_mask:0xf bank_mask:0xf
  s_nop 0
  s_nop 0
  v_max_u32_dpp v12, v12, v12 quad_perm:[2,3,0,1] row_mask:0xf bank_mask:0xf
  s_nop 0
  s_nop 0
  v_max_u32_dpp v12, v12, v12 row_half_mirror row_mask:0xf bank_mask:0xf
  s_nop 0
  s_nop 0
  v_max_u32_dpp v12, v12, v12 row_mirror row_mask:0xf bank_mask:0xf
  s_nop 0
  v_readlane_b32 s36, v12, 0
  v_readlane_b32 s37, v12, 16
  v_readlane_b32 s38, v12, 32
  v_readlane_b32 s39, v12, 48
  s_max_u32 s36, s36, s37
  s_max_u32 s38, s38, s39
  s_max_u32 s36, s36, s38
  v_writelane_b32 v14, s36, 5
  v_cmp_eq_u32 vcc, s36, v22
  s_nop 1
  v_cndmask_b32 v22, v22, v15, vcc
  v_cndmask_b32 v15, v15, v9, vcc
  s_nop 0
  v_max_u32_dpp v12, v22, v22 quad_perm:[1,0,3,2] row_mask:0xf bank_mask:0xf
  s_nop 0
  s_nop 0
  v_max_u32_dpp v12, v12, v12 quad_perm:[2,3,0,1] row_mask:0xf bank_mask:0xf
  s_nop 0
  s_nop 0
  v_max_u32_dpp v12, v12, v12 row_half_mirror row_mask:0xf bank_mask:0xf
  s_nop 0
  s_nop 0
  v_max_u32_dpp v12, v12, v12 row_mirror row_mask:0xf bank_mask:0xf
  s_nop 0
  v_readlane_b32 s36, v12, 0
  v_readlane_b32 s37, v12, 16
  v_readlane_b32 s38, v12, 32
  v_readlane_b32 s39, v12, 48
  s_max_u32 s36, s36, s37
  s_max_u32 s38, s38, s39
  s_max_u32 s36, s36, s38
  v_writelane_b32 v14, s36, 6
  v_cmp_eq_u32 vcc, s36, v22
  s_nop 1
  v_cndmask_b32 v22, v22, v15, vcc
  s_nop 0
  s_nop 0
  v_max_u32_dpp v12, v22, v22 quad_perm:[1,0,3,2] row_mask:0xf bank_mask:0xf
  s_nop 0
  s_nop 0
  v_max_u32_dpp v12, v12, v12 quad_perm:[2,3,0,1] row_mask:0xf bank_mask:0xf
  s_nop 0
  s_nop 0
  v_max_u32_dpp v12, v12, v12 row_half_mirror row_mask:0xf bank_mask:0xf
  s_nop 0
  s_nop 0
  v_max_u32_dpp v12, v12, v12 row_mirror row_mask:0xf bank_mask:0xf
  s_nop 0
  v_readlane_b32 s36, v12, 0
  v_readlane_b32 s37, v12, 16
  v_readlane_b32 s38, v12, 32
  v_readlane_b32 s39, v12, 48
  s_max_u32 s36, s36, s37
  s_max_u32 s38, s38, s39
  s_max_u32 s36, s36, s38
  v_writelane_b32 v14, s36, 7
  s_lshl_b32 s33, s13, 5
  s_add_u32 s33, s33, 0
  v_lshlrev_b32 v12, 2, v0
  v_add_u32 v12, s33, v12
  v_cmp_gt_u32 vcc, 8, v0
  s_and_saveexec_b64 s[40:41], vcc
  ds_write_b32 v12, v14
  s_mov_b64 exec, s[40:41]
  s_waitcnt lgkmcnt(0)
  s_barrier
  v_and_b32 v3, 31, v0
  v_lshlrev_b32 v3, 2, v3
  ds_read_b32 v24, v3 offset:0
  v_mov_b32 v4, 0
  ds_read_b128 v[56:59], v4 offset:0
  ds_read_b128 v[60:63], v4 offset:16
  ds_read_b128 v[64:67], v4 offset:32
  ds_read_b128 v[68:71], v4 offset:48
  ds_read_b128 v[72:75], v4 offset:64
  ds_read_b128 v[76:79], v4 offset:80
  ds_read_b128 v[80:83], v4 offset:96
  ds_read_b128 v[84:87], v4 offset:112
  v_mov_b32 v25, 0
  s_waitcnt lgkmcnt(0)
  v_cmp_gt_u32 s[60:61], v56, v24
  v_cmp_gt_u32 s[62:63], v57, v24
  v_cmp_gt_u32 s[64:65], v58, v24
  v_cmp_gt_u32 s[66:67], v59, v24
  v_addc_co_u32 v25, vcc, 0, v25, s[60:61]
  v_cmp_gt_u32 s[60:61], v60, v24
  v_addc_co_u32 v25, vcc, 0, v25, s[62:63]
  v_cmp_gt_u32 s[62:63], v61, v24
  v_addc_co_u32 v25, vcc, 0, v25, s[64:65]
  v_cmp_gt_u32 s[64:65], v62, v24
  v_addc_co_u32 v25, vcc, 0, v25, s[66:67]
  v_cmp_gt_u32 s[66:67], v63, v24
  v_addc_co_u32 v25, vcc, 0, v25, s[60:61]
  v_cmp_gt_u32 s[60:61], v64, v24
  v_addc_co_u32 v25, vcc, 0, v25, s[62:63]
  v_cmp_gt_u32 s[62:63], v65, v24
  v_addc_co_u32 v25, vcc, 0, v25, s[64:65]
  v_cmp_gt_u32 s[64:65], v66, v24
  v_addc_co_u32 v25, vcc, 0, v25, s[66:67]
  v_cmp_gt_u32 s[66:67], v67, v24
  v_addc_co_u32 v25, vcc, 0, v25, s[60:61]
  v_cmp_gt_u32 s[60:61], v68, v24
  v_addc_co_u32 v25, vcc, 0, v25, s[62:63]
  v_cmp_gt_u32 s[62:63], v69, v24
  v_addc_co_u32 v25, vcc, 0, v25, s[64:65]
  v_cmp_gt_u32 s[64:65], v70, v24
  v_addc_co_u32 v25, vcc, 0, v25, s[66:67]
  v_cmp_gt_u32 s[66:67], v71, v24
  v_addc_co_u32 v25, vcc, 0, v25, s[60:61]
  v_cmp_gt_u32 s[60:61], v72, v24
  v_addc_co_u32 v25, vcc, 0, v25, s[62:63]
  v_cmp_gt_u32 s[62:63], v73, v24
  v_addc_co_u32 v25, vcc, 0, v25, s[64:65]
  v_cmp_gt_u32 s[64:65], v74, v24
  v_addc_co_u32 v25, vcc, 0, v25, s[66:67]
  v_cmp_gt_u32 s[66:67], v75, v24
  v_addc_co_u32 v25, vcc, 0, v25, s[60:61]
  v_cmp_gt_u32 s[60:61], v76, v24
  v_addc_co_u32 v25, vcc, 0, v25, s[62:63]
  v_cmp_gt_u32 s[62:63], v77, v24
  v_addc_co_u32 v25, vcc, 0, v25, s[64:65]
  v_cmp_gt_u32 s[64:65], v78, v24
  v_addc_co_u32 v25, vcc, 0, v25, s[66:67]
  v_cmp_gt_u32 s[66:67], v79, v24
  v_addc_co_u32 v25, vcc, 0, v25, s[60:61]
  v_cmp_gt_u32 s[60:61], v80, v24
  v_addc_co_u32 v25, vcc, 0, v25, s[62:63]
  v_cmp_gt_u32 s[62:63], v81, v24
  v_addc_co_u32 v25, vcc, 0, v25, s[64:65]
  v_cmp_gt_u32 s[64:65], v82, v24
  v_addc_co_u32 v25, vcc, 0, v25, s[66:67]
  v_cmp_gt_u32 s[66:67], v83, v24
  v_addc_co_u32 v25, vcc, 0, v25, s[60:61]
  v_cmp_gt_u32 s[60:61], v84, v24
  v_addc_co_u32 v25, vcc, 0, v25, s[62:63]
  v_cmp_gt_u32 s[62:63], v85, v24
  v_addc_co_u32 v25, vcc, 0, v25, s[64:65]
  v_cmp_gt_u32 s[64:65], v86, v24
  v_addc_co_u32 v25, vcc, 0, v25, s[66:67]
  v_cmp_gt_u32 s[66:67], v87, v24
  v_addc_co_u32 v25, vcc, 0, v25, s[60:61]
  v_addc_co_u32 v25, vcc, 0, v25, s[62:63]
  v_addc_co_u32 v25, vcc, 0, v25, s[64:65]
  v_addc_co_u32 v25, vcc, 0, v25, s[66:67]
  v_cmp_gt_u32 vcc, 8, v25
  v_cmp_gt_u32 s[42:43], 32, v0
  s_and_b64 vcc, vcc, s[42:43]
  v_lshlrev_b32 v3, 2, v25
  s_and_saveexec_b64 s[40:41], vcc
  ds_write_b32 v3, v24 offset:128
  s_mov_b64 exec, s[40:41]
  s_waitcnt lgkmcnt(0)
  s_barrier
  s_cmp_ge_u32 s2, 224
  s_cbranch_scc1 t4_f2
  v_lshrrev_b32 v4, 5, v40
  v_and_b32 v5, 31, v40
  v_lshlrev_b32 v3, 2, v4
  ds_read_b32 v6, v3 offset:128
  s_waitcnt lgkmcnt(0)
  v_and_b32 v6, 0xffff, v6
  v_sub_u32 v6, 0xffff, v6
  v_lshlrev_b32 v7, 10, v6
  v_lshl_add_u32 v7, v5, 4, v7
  s_mov_b32 s14, 4194304
  s_mov_b32 s15, 6291456
  buffer_load_dwordx4 v[24:27], v7, s[20:23], s14 offen offset:0
  buffer_load_dwordx4 v[32:35], v7, s[20:23], s15 offen offset:0
  buffer_load_dwordx4 v[44:47], v7, s[16:19], 0 offen offset:0
  buffer_load_dwordx4 v[28:31], v7, s[20:23], s14 offen offset:512
  buffer_load_dwordx4 v[36:39], v7, s[20:23], s15 offen offset:512
  buffer_load_dwordx4 v[48:51], v7, s[16:19], 0 offen offset:512
  v_lshlrev_b32 v3, 3, v6
  s_mov_b32 s14, 8396800
  buffer_load_dwordx2 v[52:53], v3, s[20:23], s14 offen
  s_waitcnt vmcnt(0)
  v_sub_f32 v54, 0, v52
  v_mov_b32 v55, v54
  v_mov_b32 v52, v53
  v_lshlrev_b32 v56, 16, v24
  v_and_b32 v57, 0xffff0000, v24
  v_lshlrev_b32 v58, 16, v32
  v_and_b32 v59, 0xffff0000, v32
  v_pk_add_f32 v[56:57], v[56:57], v[58:59] neg_lo:[0,1] neg_hi:[0,1]
  v_cvt_pk_bf16_f32 v56, v56, v57
  v_and_b32 v57, 0xffff0000, v56
  v_lshlrev_b32 v56, 16, v56
  v_lshlrev_b32 v58, 16, v44
  v_and_b32 v59, 0xffff0000, v44
  v_pk_add_f32 v[56:57], v[56:57], v[58:59]
  v_cvt_pk_bf16_f32 v56, v56, v57
  v_lshlrev_b32 v64, 16, v56
  v_and_b32 v65, 0xffff0000, v56
  v_pk_add_f32 v[56:57], v[64:65], v[54:55]
  v_cvt_pk_bf16_f32 v56, v56, v57
  v_and_b32 v57, 0xffff0000, v56
  v_lshlrev_b32 v56, 16, v56
  v_pk_mul_f32 v[56:57], v[56:57], v[52:53]
  v_cvt_pk_bf16_f32 v80, v56, v57
  v_lshlrev_b32 v56, 16, v25
  v_and_b32 v57, 0xffff0000, v25
  v_lshlrev_b32 v58, 16, v33
  v_and_b32 v59, 0xffff0000, v33
  v_pk_add_f32 v[56:57], v[56:57], v[58:59] neg_lo:[0,1] neg_hi:[0,1]
  v_cvt_pk_bf16_f32 v56, v56, v57
  v_and_b32 v57, 0xffff0000, v56
  v_lshlrev_b32 v56, 16, v56
  v_lshlrev_b32 v58, 16, v45
  v_and_b32 v59, 0xffff0000, v45
  v_pk_add_f32 v[56:57], v[56:57], v[58:59]
  v_cvt_pk_bf16_f32 v56, v56, v57
  v_lshlrev_b32 v66, 16, v56
  v_and_b32 v67, 0xffff0000, v56
  v_pk_add_f32 v[56:57], v[66:67], v[54:55]
  v_cvt_pk_bf16_f32 v56, v56, v57
  v_and_b32 v57, 0xffff0000, v56
  v_lshlrev_b32 v56, 16, v56
  v_pk_mul_f32 v[56:57], v[56:57], v[52:53]
  v_cvt_pk_bf16_f32 v81, v56, v57
  v_lshlrev_b32 v56, 16, v26
  v_and_b32 v57, 0xffff0000, v26
  v_lshlrev_b32 v58, 16, v34
  v_and_b32 v59, 0xffff0000, v34
  v_pk_add_f32 v[56:57], v[56:57], v[58:59] neg_lo:[0,1] neg_hi:[0,1]
  v_cvt_pk_bf16_f32 v56, v56, v57
  v_and_b32 v57, 0xffff0000, v56
  v_lshlrev_b32 v56, 16, v56
  v_lshlrev_b32 v58, 16, v46
  v_and_b32 v59, 0xffff0000, v46
  v_pk_add_f32 v[56:57], v[56:57], v[58:59]
  v_cvt_pk_bf16_f32 v56, v56, v57
  v_lshlrev_b32 v68, 16, v56
  v_and_b32 v69, 0xffff0000, v56
  v_pk_add_f32 v[56:57], v[68:69], v[54:55]
  v_cvt_pk_bf16_f32 v56, v56, v57
  v_and_b32 v57, 0xffff0000, v56
  v_lshlrev_b32 v56, 16, v56
  v_pk_mul_f32 v[56:57], v[56:57], v[52:53]
  v_cvt_pk_bf16_f32 v82, v56, v57
  v_lshlrev_b32 v56, 16, v27
  v_and_b32 v57, 0xffff0000, v27
  v_lshlrev_b32 v58, 16, v35
  v_and_b32 v59, 0xffff0000, v35
  v_pk_add_f32 v[56:57], v[56:57], v[58:59] neg_lo:[0,1] neg_hi:[0,1]
  v_cvt_pk_bf16_f32 v56, v56, v57
  v_and_b32 v57, 0xffff0000, v56
  v_lshlrev_b32 v56, 16, v56
  v_lshlrev_b32 v58, 16, v47
  v_and_b32 v59, 0xffff0000, v47
  v_pk_add_f32 v[56:57], v[56:57], v[58:59]
  v_cvt_pk_bf16_f32 v56, v56, v57
  v_lshlrev_b32 v70, 16, v56
  v_and_b32 v71, 0xffff0000, v56
  v_pk_add_f32 v[56:57], v[70:71], v[54:55]
  v_cvt_pk_bf16_f32 v56, v56, v57
  v_and_b32 v57, 0xffff0000, v56
  v_lshlrev_b32 v56, 16, v56
  v_pk_mul_f32 v[56:57], v[56:57], v[52:53]
  v_cvt_pk_bf16_f32 v83, v56, v57
  v_lshlrev_b32 v56, 16, v28
  v_and_b32 v57, 0xffff0000, v28
  v_lshlrev_b32 v58, 16, v36
  v_and_b32 v59, 0xffff0000, v36
  v_pk_add_f32 v[56:57], v[56:57], v[58:59] neg_lo:[0,1] neg_hi:[0,1]
  v_cvt_pk_bf16_f32 v56, v56, v57
  v_and_b32 v57, 0xffff0000, v56
  v_lshlrev_b32 v56, 16, v56
  v_lshlrev_b32 v58, 16, v48
  v_and_b32 v59, 0xffff0000, v48
  v_pk_add_f32 v[56:57], v[56:57], v[58:59]
  v_cvt_pk_bf16_f32 v56, v56, v57
  v_lshlrev_b32 v72, 16, v56
  v_and_b32 v73, 0xffff0000, v56
  v_pk_add_f32 v[56:57], v[72:73], v[54:55]
  v_cvt_pk_bf16_f32 v56, v56, v57
  v_and_b32 v57, 0xffff0000, v56
  v_lshlrev_b32 v56, 16, v56
  v_pk_mul_f32 v[56:57], v[56:57], v[52:53]
  v_cvt_pk_bf16_f32 v84, v56, v57
  v_lshlrev_b32 v56, 16, v29
  v_and_b32 v57, 0xffff0000, v29
  v_lshlrev_b32 v58, 16, v37
  v_and_b32 v59, 0xffff0000, v37
  v_pk_add_f32 v[56:57], v[56:57], v[58:59] neg_lo:[0,1] neg_hi:[0,1]
  v_cvt_pk_bf16_f32 v56, v56, v57
  v_and_b32 v57, 0xffff0000, v56
  v_lshlrev_b32 v56, 16, v56
  v_lshlrev_b32 v58, 16, v49
  v_and_b32 v59, 0xffff0000, v49
  v_pk_add_f32 v[56:57], v[56:57], v[58:59]
  v_cvt_pk_bf16_f32 v56, v56, v57
  v_lshlrev_b32 v74, 16, v56
  v_and_b32 v75, 0xffff0000, v56
  v_pk_add_f32 v[56:57], v[74:75], v[54:55]
  v_cvt_pk_bf16_f32 v56, v56, v57
  v_and_b32 v57, 0xffff0000, v56
  v_lshlrev_b32 v56, 16, v56
  v_pk_mul_f32 v[56:57], v[56:57], v[52:53]
  v_cvt_pk_bf16_f32 v85, v56, v57
  v_lshlrev_b32 v56, 16, v30
  v_and_b32 v57, 0xffff0000, v30
  v_lshlrev_b32 v58, 16, v38
  v_and_b32 v59, 0xffff0000, v38
  v_pk_add_f32 v[56:57], v[56:57], v[58:59] neg_lo:[0,1] neg_hi:[0,1]
  v_cvt_pk_bf16_f32 v56, v56, v57
  v_and_b32 v57, 0xffff0000, v56
  v_lshlrev_b32 v56, 16, v56
  v_lshlrev_b32 v58, 16, v50
  v_and_b32 v59, 0xffff0000, v50
  v_pk_add_f32 v[56:57], v[56:57], v[58:59]
  v_cvt_pk_bf16_f32 v56, v56, v57
  v_lshlrev_b32 v76, 16, v56
  v_and_b32 v77, 0xffff0000, v56
  v_pk_add_f32 v[56:57], v[76:77], v[54:55]
  v_cvt_pk_bf16_f32 v56, v56, v57
  v_and_b32 v57, 0xffff0000, v56
  v_lshlrev_b32 v56, 16, v56
  v_pk_mul_f32 v[56:57], v[56:57], v[52:53]
  v_cvt_pk_bf16_f32 v86, v56, v57
  v_lshlrev_b32 v56, 16, v31
  v_and_b32 v57, 0xffff0000, v31
  v_lshlrev_b32 v58, 16, v39
  v_and_b32 v59, 0xffff0000, v39
  v_pk_add_f32 v[56:57], v[56:57], v[58:59] neg_lo:[0,1] neg_hi:[0,1]
  v_cvt_pk_bf16_f32 v56, v56, v57
  v_and_b32 v57, 0xffff0000, v56
  v_lshlrev_b32 v56, 16, v56
  v_lshlrev_b32 v58, 16, v51
  v_and_b32 v59, 0xffff0000, v51
  v_pk_add_f32 v[56:57], v[56:57], v[58:59]
  v_cvt_pk_bf16_f32 v56, v56, v57
  v_lshlrev_b32 v78, 16, v56
  v_and_b32 v79, 0xffff0000, v56
  v_pk_add_f32 v[56:57], v[78:79], v[54:55]
  v_cvt_pk_bf16_f32 v56, v56, v57
  v_and_b32 v57, 0xffff0000, v56
  v_lshlrev_b32 v56, 16, v56
  v_pk_mul_f32 v[56:57], v[56:57], v[52:53]
  v_cvt_pk_bf16_f32 v87, v56, v57
  v_mul_u32_u24 v3, 1040, v4
  v_lshl_add_u32 v3, v5, 4, v3
  ds_write_b128 v3, v[80:83] offset:25088
  ds_write_b128 v3, v[84:87] offset:25600
  s_waitcnt lgkmcnt(0)
  s_barrier
  s_cmp_lg_u32 s13, 0
  s_cbranch_scc1 t4_done
  v_and_b32 v3, 7, v0
  v_mul_u32_u24 v3, 1040, v3
  v_lshrrev_b32 v4, 4, v0
  v_lshl_add_u32 v3, v4, 4, v3
  v_and_b32 v5, 15, v0
  v_lshrrev_b32 v5, 2, v5
  v_lshl_add_u32 v5, v4, 3, v5
  v_lshlrev_b32 v5, 4, v5
  v_and_b32 v6, 1, v0
  v_lshl_add_u32 v5, v6, 3, v5
  v_and_b32 v6, 2, v0
  v_lshl_add_u32 v5, v6, 12, v5
  v_mov_b32 v8, 0
  v_mov_b32 v9, 0
  v_mov_b32 v10, 0
  v_mov_b32 v11, 0
  ds_read_b128 v[64:67], v3 offset:25088
  ds_read_b64_tr_b16 v[128:129], v5 offset:8704
  ds_read_b64_tr_b16 v[130:131], v5 offset:8768
  ds_read_b128 v[68:71], v3 offset:25152
  ds_read_b64_tr_b16 v[132:133], v5 offset:9216
  ds_read_b64_tr_b16 v[134:135], v5 offset:9280
  ds_read_b128 v[72:75], v3 offset:25216
  ds_read_b64_tr_b16 v[136:137], v5 offset:9728
  ds_read_b64_tr_b16 v[138:139], v5 offset:9792
  ds_read_b128 v[76:79], v3 offset:25280
  ds_read_b64_tr_b16 v[140:141], v5 offset:10240
  ds_read_b64_tr_b16 v[142:143], v5 offset:10304
  s_waitcnt lgkmcnt(0)
  v_mfma_f32_16x16x32_bf16 v[8:11], v[64:67], v[128:131], v[8:11]
  v_mfma_f32_16x16x32_bf16 v[8:11], v[68:71], v[132:135], v[8:11]
  v_mfma_f32_16x16x32_bf16 v[8:11], v[72:75], v[136:139], v[8:11]
  v_mfma_f32_16x16x32_bf16 v[8:11], v[76:79], v[140:143], v[8:11]
  ds_read_b128 v[80:83], v3 offset:25344
  ds_read_b64_tr_b16 v[144:145], v5 offset:10752
  ds_read_b64_tr_b16 v[146:147], v5 offset:10816
  ds_read_b128 v[84:87], v3 offset:25408
  ds_read_b64_tr_b16 v[148:149], v5 offset:11264
  ds_read_b64_tr_b16 v[150:151], v5 offset:11328
  ds_read_b128 v[88:91], v3 offset:25472
  ds_read_b64_tr_b16 v[152:153], v5 offset:11776
  ds_read_b64_tr_b16 v[154:155], v5 offset:11840
  ds_read_b128 v[92:95], v3 offset:25536
  ds_read_b64_tr_b16 v[156:157], v5 offset:12288
  ds_read_b64_tr_b16 v[158:159], v5 offset:12352
  s_waitcnt lgkmcnt(0)
  v_mfma_f32_16x16x32_bf16 v[8:11], v[80:83], v[144:147], v[8:11]
  v_mfma_f32_16x16x32_bf16 v[8:11], v[84:87], v[148:151], v[8:11]
  v_mfma_f32_16x16x32_bf16 v[8:11], v[88:91], v[152:155], v[8:11]
  v_mfma_f32_16x16x32_bf16 v[8:11], v[92:95], v[156:159], v[8:11]
  ds_read_b128 v[96:99], v3 offset:25600
  ds_read_b64_tr_b16 v[160:161], v5 offset:12800
  ds_read_b64_tr_b16 v[162:163], v5 offset:12864
  ds_read_b128 v[100:103], v3 offset:25664
  ds_read_b64_tr_b16 v[164:165], v5 offset:13312
  ds_read_b64_tr_b16 v[166:167], v5 offset:13376
  ds_read_b128 v[104:107], v3 offset:25728
  ds_read_b64_tr_b16 v[168:169], v5 offset:13824
  ds_read_b64_tr_b16 v[170:171], v5 offset:13888
  ds_read_b128 v[108:111], v3 offset:25792
  ds_read_b64_tr_b16 v[172:173], v5 offset:14336
  ds_read_b64_tr_b16 v[174:175], v5 offset:14400
  s_waitcnt lgkmcnt(0)
  v_mfma_f32_16x16x32_bf16 v[8:11], v[96:99], v[160:163], v[8:11]
  v_mfma_f32_16x16x32_bf16 v[8:11], v[100:103], v[164:167], v[8:11]
  v_mfma_f32_16x16x32_bf16 v[8:11], v[104:107], v[168:171], v[8:11]
  v_mfma_f32_16x16x32_bf16 v[8:11], v[108:111], v[172:175], v[8:11]
  ds_read_b128 v[112:115], v3 offset:25856
  ds_read_b64_tr_b16 v[176:177], v5 offset:14848
  ds_read_b64_tr_b16 v[178:179], v5 offset:14912
  ds_read_b128 v[116:119], v3 offset:25920
  ds_read_b64_tr_b16 v[180:181], v5 offset:15360
  ds_read_b64_tr_b16 v[182:183], v5 offset:15424
  ds_read_b128 v[120:123], v3 offset:25984
  ds_read_b64_tr_b16 v[184:185], v5 offset:15872
  ds_read_b64_tr_b16 v[186:187], v5 offset:15936
  ds_read_b128 v[124:127], v3 offset:26048
  ds_read_b64_tr_b16 v[188:189], v5 offset:16384
  ds_read_b64_tr_b16 v[190:191], v5 offset:16448
  s_waitcnt lgkmcnt(0)
  v_mfma_f32_16x16x32_bf16 v[8:11], v[112:115], v[176:179], v[8:11]
  v_mfma_f32_16x16x32_bf16 v[8:11], v[116:119], v[180:183], v[8:11]
  v_mfma_f32_16x16x32_bf16 v[8:11], v[120:123], v[184:187], v[8:11]
  v_mfma_f32_16x16x32_bf16 v[8:11], v[124:127], v[188:191], v[8:11]
  s_nop 15
  v_cvt_pk_bf16_f32 v8, v8, v8
  v_lshlrev_b32 v8, 16, v8
  v_cvt_pk_bf16_f32 v9, v9, v9
  v_lshlrev_b32 v9, 16, v9
  v_cvt_pk_bf16_f32 v10, v10, v10
  v_lshlrev_b32 v10, 16, v10
  v_cvt_pk_bf16_f32 v11, v11, v11
  v_lshlrev_b32 v11, 16, v11
  s_nop 1
  v_mov_b32_dpp v12, v8 row_ror:8 row_mask:0xf bank_mask:0xf
  v_mov_b32_dpp v13, v9 row_ror:8 row_mask:0xf bank_mask:0xf
  v_mov_b32_dpp v14, v10 row_ror:8 row_mask:0xf bank_mask:0xf
  v_mov_b32_dpp v15, v11 row_ror:8 row_mask:0xf bank_mask:0xf
  v_mul_f32 v16, 0xbfb8aa3b, v8
  v_exp_f32 v16, v16
  s_nop 0
  v_add_f32 v16, 1.0, v16
  v_rcp_f32 v16, v16
  s_nop 0
  v_mul_f32 v16, v8, v16
  v_cvt_pk_bf16_f32 v16, v16, v16
  v_lshlrev_b32 v16, 16, v16
  v_mul_f32 v16, v16, v12
  v_cvt_pk_bf16_f32 v20, v16, v16
  v_mul_f32 v16, 0xbfb8aa3b, v9
  v_exp_f32 v16, v16
  s_nop 0
  v_add_f32 v16, 1.0, v16
  v_rcp_f32 v16, v16
  s_nop 0
  v_mul_f32 v16, v9, v16
  v_cvt_pk_bf16_f32 v16, v16, v16
  v_lshlrev_b32 v16, 16, v16
  v_mul_f32 v16, v16, v13
  v_cvt_pk_bf16_f32 v21, v16, v16
  v_mul_f32 v16, 0xbfb8aa3b, v10
  v_exp_f32 v16, v16
  s_nop 0
  v_add_f32 v16, 1.0, v16
  v_rcp_f32 v16, v16
  s_nop 0
  v_mul_f32 v16, v10, v16
  v_cvt_pk_bf16_f32 v16, v16, v16
  v_lshlrev_b32 v16, 16, v16
  v_mul_f32 v16, v16, v14
  v_cvt_pk_bf16_f32 v22, v16, v16
  v_mul_f32 v16, 0xbfb8aa3b, v11
  v_exp_f32 v16, v16
  s_nop 0
  v_add_f32 v16, 1.0, v16
  v_rcp_f32 v16, v16
  s_nop 0
  v_mul_f32 v16, v11, v16
  v_cvt_pk_bf16_f32 v16, v16, v16
  v_lshlrev_b32 v16, 16, v16
  v_mul_f32 v16, v16, v15
  v_cvt_pk_bf16_f32 v23, v16, v16
  s_nop 1
  v_mov_b32_dpp v24, v20 quad_perm:[1,0,3,2] row_mask:0xf bank_mask:0xf
  v_mov_b32_dpp v25, v21 quad_perm:[1,0,3,2] row_mask:0xf bank_mask:0xf
  v_mov_b32_dpp v26, v22 quad_perm:[1,0,3,2] row_mask:0xf bank_mask:0xf
  v_mov_b32_dpp v27, v23 quad_perm:[1,0,3,2] row_mask:0xf bank_mask:0xf
  v_and_b32 v20, 0xffff, v20
  v_and_b32 v24, 0xffff0000, v24
  v_or_b32 v20, v20, v24
  v_and_b32 v21, 0xffff, v21
  v_and_b32 v25, 0xffff0000, v25
  v_or_b32 v21, v21, v25
  v_and_b32 v22, 0xffff, v22
  v_and_b32 v26, 0xffff0000, v26
  v_or_b32 v22, v22, v26
  v_and_b32 v23, 0xffff, v23
  v_and_b32 v27, 0xffff0000, v27
  v_or_b32 v23, v23, v27
  v_min_u32 v20, 0xfffeffff, v20
  v_min_u32 v21, 0xfffeffff, v21
  v_min_u32 v22, 0xfffeffff, v22
  v_min_u32 v23, 0xfffeffff, v23
  v_and_b32 v5, 15, v0
  v_lshlrev_b32 v4, 6, v4
  v_lshl_add_u32 v4, v5, 1, v4
  v_lshlrev_b32 v7, 4, v0
  v_and_b32 v6, 9, v0
  v_cmp_eq_u32 vcc, 0, v6
  v_cmp_gt_u32 s[42:43], 32, v0
  s_and_b64 vcc, vcc, s[42:43]
  s_and_saveexec_b64 s[40:41], vcc
  ds_write_b32 v4, v20 offset:256
  ds_write_b32 v4, v21 offset:272
  ds_write_b32 v4, v22 offset:288
  ds_write_b32 v4, v23 offset:304
  s_mov_b64 exec, 0xff
  s_waitcnt lgkmcnt(0)
  ds_read_b128 v[24:27], v7 offset:256
  s_lshl_b32 s15, s3, 7
  s_add_u32 s15, s15, 8454144
  s_waitcnt lgkmcnt(0)
  buffer_store_dwordx4 v[24:27], v7, s[20:23], s15 offen sc1
  s_branch t4_done
t4_f2:
  v_lshrrev_b32 v5, 4, v0
  v_and_b32 v6, 1, v5
  v_lshlrev_b32 v6, 4, v6
  ds_read_b128 v[24:27], v6 offset:128
  v_and_b32 v6, 15, v0
  s_lshl_b32 s15, s46, 6
  s_waitcnt lgkmcnt(0)
  v_and_b32 v28, 0xffff, v24
  v_sub_u32 v28, 0xffff, v28
  v_lshlrev_b32 v32, 3, v28
  v_lshlrev_b32 v28, 10, v28
  v_lshl_add_u32 v28, v6, 1, v28
  v_add_u32 v28, s15, v28
  v_and_b32 v29, 0xffff, v25
  v_sub_u32 v29, 0xffff, v29
  v_lshlrev_b32 v33, 3, v29
  v_lshlrev_b32 v29, 10, v29
  v_lshl_add_u32 v29, v6, 1, v29
  v_add_u32 v29, s15, v29
  v_and_b32 v30, 0xffff, v26
  v_sub_u32 v30, 0xffff, v30
  v_lshlrev_b32 v34, 3, v30
  v_lshlrev_b32 v30, 10, v30
  v_lshl_add_u32 v30, v6, 1, v30
  v_add_u32 v30, s15, v30
  v_and_b32 v31, 0xffff, v27
  v_sub_u32 v31, 0xffff, v31
  v_lshlrev_b32 v35, 3, v31
  v_lshlrev_b32 v31, 10, v31
  v_lshl_add_u32 v31, v6, 1, v31
  v_add_u32 v31, s15, v31
  s_cmp_lg_u32 s13, 0
  s_cbranch_scc1 t4_noepi
  s_mov_b32 s36, 4194304
  s_mov_b32 s37, 6291456
  s_mov_b32 s38, 8396800
  buffer_load_ushort v192, v28, s[20:23], s36 offen offset:0
  buffer_load_ushort v196, v28, s[20:23], s37 offen offset:0
  buffer_load_ushort v200, v28, s[16:19], 0 offen offset:0
  buffer_load_ushort v193, v29, s[20:23], s36 offen offset:0
  buffer_load_ushort v197, v29, s[20:23], s37 offen offset:0
  buffer_load_ushort v201, v29, s[16:19], 0 offen offset:0
  buffer_load_ushort v194, v30, s[20:23], s36 offen offset:0
  buffer_load_ushort v198, v30, s[20:23], s37 offen offset:0
  buffer_load_ushort v202, v30, s[16:19], 0 offen offset:0
  buffer_load_ushort v195, v31, s[20:23], s36 offen offset:0
  buffer_load_ushort v199, v31, s[20:23], s37 offen offset:0
  buffer_load_ushort v203, v31, s[16:19], 0 offen offset:0
  buffer_load_ushort v204, v28, s[20:23], s36 offen offset:32
  buffer_load_ushort v208, v28, s[20:23], s37 offen offset:32
  buffer_load_ushort v212, v28, s[16:19], 0 offen offset:32
  buffer_load_ushort v205, v29, s[20:23], s36 offen offset:32
  buffer_load_ushort v209, v29, s[20:23], s37 offen offset:32
  buffer_load_ushort v213, v29, s[16:19], 0 offen offset:32
  buffer_load_ushort v206, v30, s[20:23], s36 offen offset:32
  buffer_load_ushort v210, v30, s[20:23], s37 offen offset:32
  buffer_load_ushort v214, v30, s[16:19], 0 offen offset:32
  buffer_load_ushort v207, v31, s[20:23], s36 offen offset:32
  buffer_load_ushort v211, v31, s[20:23], s37 offen offset:32
  buffer_load_ushort v215, v31, s[16:19], 0 offen offset:32
  buffer_load_dwordx2 v[48:49], v32, s[20:23], s38 offen
  buffer_load_dwordx2 v[50:51], v33, s[20:23], s38 offen
  buffer_load_dwordx2 v[52:53], v34, s[20:23], s38 offen
  buffer_load_dwordx2 v[54:55], v35, s[20:23], s38 offen
t4_noepi:
  v_lshrrev_b32 v7, 2, v6
  v_lshl_add_u32 v7, v5, 3, v7
  v_lshlrev_b32 v7, 4, v7
  v_and_b32 v60, 1, v0
  v_lshl_add_u32 v7, v60, 3, v7
  v_and_b32 v60, 2, v0
  v_mul_u32_u24 v60, 14336, v60
  v_add_u32 v7, v60, v7
  v_add_u32 v7, s34, v7
  v_add_u32 v61, 57344, v7
  s_waitcnt vmcnt(0)
  ds_read_b64_tr_b16 v[72:73], v7 offset:8704
  ds_read_b64_tr_b16 v[74:75], v7 offset:8768
  ds_read_b64_tr_b16 v[128:129], v61 offset:8704
  ds_read_b64_tr_b16 v[130:131], v61 offset:8768
  ds_read_b64_tr_b16 v[76:77], v7 offset:9216
  ds_read_b64_tr_b16 v[78:79], v7 offset:9280
  ds_read_b64_tr_b16 v[132:133], v61 offset:9216
  ds_read_b64_tr_b16 v[134:135], v61 offset:9280
  ds_read_b64_tr_b16 v[80:81], v7 offset:9728
  ds_read_b64_tr_b16 v[82:83], v7 offset:9792
  ds_read_b64_tr_b16 v[136:137], v61 offset:9728
  ds_read_b64_tr_b16 v[138:139], v61 offset:9792
  s_waitcnt lgkmcnt(0)
  ds_read_b64_tr_b16 v[84:85], v7 offset:10240
  ds_read_b64_tr_b16 v[86:87], v7 offset:10304
  ds_read_b64_tr_b16 v[140:141], v61 offset:10240
  ds_read_b64_tr_b16 v[142:143], v61 offset:10304
  ds_read_b64_tr_b16 v[88:89], v7 offset:10752
  ds_read_b64_tr_b16 v[90:91], v7 offset:10816
  ds_read_b64_tr_b16 v[144:145], v61 offset:10752
  ds_read_b64_tr_b16 v[146:147], v61 offset:10816
  ds_read_b64_tr_b16 v[92:93], v7 offset:11264
  ds_read_b64_tr_b16 v[94:95], v7 offset:11328
  ds_read_b64_tr_b16 v[148:149], v61 offset:11264
  ds_read_b64_tr_b16 v[150:151], v61 offset:11328
  s_waitcnt lgkmcnt(0)
  ds_read_b64_tr_b16 v[96:97], v7 offset:11776
  ds_read_b64_tr_b16 v[98:99], v7 offset:11840
  ds_read_b64_tr_b16 v[152:153], v61 offset:11776
  ds_read_b64_tr_b16 v[154:155], v61 offset:11840
  ds_read_b64_tr_b16 v[100:101], v7 offset:12288
  ds_read_b64_tr_b16 v[102:103], v7 offset:12352
  ds_read_b64_tr_b16 v[156:157], v61 offset:12288
  ds_read_b64_tr_b16 v[158:159], v61 offset:12352
  ds_read_b64_tr_b16 v[104:105], v7 offset:12800
  ds_read_b64_tr_b16 v[106:107], v7 offset:12864
  ds_read_b64_tr_b16 v[160:161], v61 offset:12800
  ds_read_b64_tr_b16 v[162:163], v61 offset:12864
  s_waitcnt lgkmcnt(0)
  ds_read_b64_tr_b16 v[108:109], v7 offset:13312
  ds_read_b64_tr_b16 v[110:111], v7 offset:13376
  ds_read_b64_tr_b16 v[164:165], v61 offset:13312
  ds_read_b64_tr_b16 v[166:167], v61 offset:13376
  ds_read_b64_tr_b16 v[112:113], v7 offset:13824
  ds_read_b64_tr_b16 v[114:115], v7 offset:13888
  ds_read_b64_tr_b16 v[168:169], v61 offset:13824
  ds_read_b64_tr_b16 v[170:171], v61 offset:13888
  ds_read_b64_tr_b16 v[116:117], v7 offset:14336
  ds_read_b64_tr_b16 v[118:119], v7 offset:14400
  ds_read_b64_tr_b16 v[172:173], v61 offset:14336
  ds_read_b64_tr_b16 v[174:175], v61 offset:14400
  s_waitcnt lgkmcnt(0)
  ds_read_b64_tr_b16 v[120:121], v7 offset:14848
  ds_read_b64_tr_b16 v[122:123], v7 offset:14912
  ds_read_b64_tr_b16 v[176:177], v61 offset:14848
  ds_read_b64_tr_b16 v[178:179], v61 offset:14912
  ds_read_b64_tr_b16 v[124:125], v7 offset:15360
  ds_read_b64_tr_b16 v[126:127], v7 offset:15424
  ds_read_b64_tr_b16 v[180:181], v61 offset:15360
  ds_read_b64_tr_b16 v[182:183], v61 offset:15424
  v_mov_b32 v8, 0
  v_mov_b32 v9, 0
  v_mov_b32 v10, 0
  v_mov_b32 v11, 0
  v_mov_b32 v12, 0
  v_mov_b32 v13, 0
  v_mov_b32 v14, 0
  v_mov_b32 v15, 0
  v_and_b32 v60, 0xffff0000, v24
  v_ashrrev_i32 v62, 31, v60
  v_not_b32 v62, v62
  v_or_b32 v62, 0x80000000, v62
  v_xor_b32 v60, v60, v62
  v_and_b32 v60, 0xffff0000, v60
  v_mul_f32 v60, 0xbfb8aa3b, v60
  v_exp_f32 v60, v60
  s_nop 0
  v_add_f32 v60, 1.0, v60
  v_rcp_f32 v60, v60
  s_nop 0
  v_cvt_pk_bf16_f32 v60, v60, v60
  v_lshlrev_b32 v24, 16, v60
  v_and_b32 v60, 0xffff0000, v25
  v_ashrrev_i32 v62, 31, v60
  v_not_b32 v62, v62
  v_or_b32 v62, 0x80000000, v62
  v_xor_b32 v60, v60, v62
  v_and_b32 v60, 0xffff0000, v60
  v_mul_f32 v60, 0xbfb8aa3b, v60
  v_exp_f32 v60, v60
  s_nop 0
  v_add_f32 v60, 1.0, v60
  v_rcp_f32 v60, v60
  s_nop 0
  v_cvt_pk_bf16_f32 v60, v60, v60
  v_lshlrev_b32 v25, 16, v60
  v_and_b32 v60, 0xffff0000, v26
  v_ashrrev_i32 v62, 31, v60
  v_not_b32 v62, v62
  v_or_b32 v62, 0x80000000, v62
  v_xor_b32 v60, v60, v62
  v_and_b32 v60, 0xffff0000, v60
  v_mul_f32 v60, 0xbfb8aa3b, v60
  v_exp_f32 v60, v60
  s_nop 0
  v_add_f32 v60, 1.0, v60
  v_rcp_f32 v60, v60
  s_nop 0
  v_cvt_pk_bf16_f32 v60, v60, v60
  v_lshlrev_b32 v26, 16, v60
  v_and_b32 v60, 0xffff0000, v27
  v_ashrrev_i32 v62, 31, v60
  v_not_b32 v62, v62
  v_or_b32 v62, 0x80000000, v62
  v_xor_b32 v60, v60, v62
  v_and_b32 v60, 0xffff0000, v60
  v_mul_f32 v60, 0xbfb8aa3b, v60
  v_exp_f32 v60, v60
  s_nop 0
  v_add_f32 v60, 1.0, v60
  v_rcp_f32 v60, v60
  s_nop 0
  v_cvt_pk_bf16_f32 v60, v60, v60
  v_lshlrev_b32 v27, 16, v60
  v_lshlrev_b32 v192, 16, v192
  v_lshlrev_b32 v196, 16, v196
  v_lshlrev_b32 v200, 16, v200
  v_sub_f32 v60, v192, v196
  v_cvt_pk_bf16_f32 v60, v60, v60
  v_lshlrev_b32 v60, 16, v60
  v_add_f32 v60, v200, v60
  v_cvt_pk_bf16_f32 v60, v60, v60
  v_lshlrev_b32 v192, 16, v60
  v_sub_f32 v62, v192, v48
  v_cvt_pk_bf16_f32 v62, v62, v62
  v_lshlrev_b32 v62, 16, v62
  v_mul_f32 v62, v62, v49
  v_cvt_pk_bf16_f32 v62, v62, v62
  v_lshlrev_b32 v196, 16, v62
  v_lshlrev_b32 v193, 16, v193
  v_lshlrev_b32 v197, 16, v197
  v_lshlrev_b32 v201, 16, v201
  v_sub_f32 v60, v193, v197
  v_cvt_pk_bf16_f32 v60, v60, v60
  v_lshlrev_b32 v60, 16, v60
  v_add_f32 v60, v201, v60
  v_cvt_pk_bf16_f32 v60, v60, v60
  v_lshlrev_b32 v193, 16, v60
  v_sub_f32 v62, v193, v50
  v_cvt_pk_bf16_f32 v62, v62, v62
  v_lshlrev_b32 v62, 16, v62
  v_mul_f32 v62, v62, v51
  v_cvt_pk_bf16_f32 v62, v62, v62
  v_lshlrev_b32 v197, 16, v62
  v_lshlrev_b32 v194, 16, v194
  v_lshlrev_b32 v198, 16, v198
  v_lshlrev_b32 v202, 16, v202
  v_sub_f32 v60, v194, v198
  v_cvt_pk_bf16_f32 v60, v60, v60
  v_lshlrev_b32 v60, 16, v60
  v_add_f32 v60, v202, v60
  v_cvt_pk_bf16_f32 v60, v60, v60
  v_lshlrev_b32 v194, 16, v60
  v_sub_f32 v62, v194, v52
  v_cvt_pk_bf16_f32 v62, v62, v62
  v_lshlrev_b32 v62, 16, v62
  v_mul_f32 v62, v62, v53
  v_cvt_pk_bf16_f32 v62, v62, v62
  v_lshlrev_b32 v198, 16, v62
  v_lshlrev_b32 v195, 16, v195
  v_lshlrev_b32 v199, 16, v199
  v_lshlrev_b32 v203, 16, v203
  v_sub_f32 v60, v195, v199
  v_cvt_pk_bf16_f32 v60, v60, v60
  v_lshlrev_b32 v60, 16, v60
  v_add_f32 v60, v203, v60
  v_cvt_pk_bf16_f32 v60, v60, v60
  v_lshlrev_b32 v195, 16, v60
  v_sub_f32 v62, v195, v54
  v_cvt_pk_bf16_f32 v62, v62, v62
  v_lshlrev_b32 v62, 16, v62
  v_mul_f32 v62, v62, v55
  v_cvt_pk_bf16_f32 v62, v62, v62
  v_lshlrev_b32 v199, 16, v62
  v_lshlrev_b32 v204, 16, v204
  v_lshlrev_b32 v208, 16, v208
  v_lshlrev_b32 v212, 16, v212
  v_sub_f32 v60, v204, v208
  v_cvt_pk_bf16_f32 v60, v60, v60
  v_lshlrev_b32 v60, 16, v60
  v_add_f32 v60, v212, v60
  v_cvt_pk_bf16_f32 v60, v60, v60
  v_lshlrev_b32 v204, 16, v60
  v_sub_f32 v62, v204, v48
  v_cvt_pk_bf16_f32 v62, v62, v62
  v_lshlrev_b32 v62, 16, v62
  v_mul_f32 v62, v62, v49
  v_cvt_pk_bf16_f32 v62, v62, v62
  v_lshlrev_b32 v208, 16, v62
  v_lshlrev_b32 v205, 16, v205
  v_lshlrev_b32 v209, 16, v209
  v_lshlrev_b32 v213, 16, v213
  v_sub_f32 v60, v205, v209
  v_cvt_pk_bf16_f32 v60, v60, v60
  v_lshlrev_b32 v60, 16, v60
  v_add_f32 v60, v213, v60
  v_cvt_pk_bf16_f32 v60, v60, v60
  v_lshlrev_b32 v205, 16, v60
  v_sub_f32 v62, v205, v50
  v_cvt_pk_bf16_f32 v62, v62, v62
  v_lshlrev_b32 v62, 16, v62
  v_mul_f32 v62, v62, v51
  v_cvt_pk_bf16_f32 v62, v62, v62
  v_lshlrev_b32 v209, 16, v62
  v_lshlrev_b32 v206, 16, v206
  v_lshlrev_b32 v210, 16, v210
  v_lshlrev_b32 v214, 16, v214
  v_sub_f32 v60, v206, v210
  v_cvt_pk_bf16_f32 v60, v60, v60
  v_lshlrev_b32 v60, 16, v60
  v_add_f32 v60, v214, v60
  v_cvt_pk_bf16_f32 v60, v60, v60
  v_lshlrev_b32 v206, 16, v60
  v_sub_f32 v62, v206, v52
  v_cvt_pk_bf16_f32 v62, v62, v62
  v_lshlrev_b32 v62, 16, v62
  v_mul_f32 v62, v62, v53
  v_cvt_pk_bf16_f32 v62, v62, v62
  v_lshlrev_b32 v210, 16, v62
  v_lshlrev_b32 v207, 16, v207
  v_lshlrev_b32 v211, 16, v211
  v_lshlrev_b32 v215, 16, v215
  v_sub_f32 v60, v207, v211
  v_cvt_pk_bf16_f32 v60, v60, v60
  v_lshlrev_b32 v60, 16, v60
  v_add_f32 v60, v215, v60
  v_cvt_pk_bf16_f32 v60, v60, v60
  v_lshlrev_b32 v207, 16, v60
  v_sub_f32 v62, v207, v54
  v_cvt_pk_bf16_f32 v62, v62, v62
  v_lshlrev_b32 v62, 16, v62
  v_mul_f32 v62, v62, v55
  v_cvt_pk_bf16_f32 v62, v62, v62
  v_lshlrev_b32 v211, 16, v62
  v_and_b32 v4, 7, v0
  v_lshlrev_b32 v4, 4, v4
  v_lshl_add_u32 v4, v5, 7, v4
  s_mul_i32 s14, s13, 7168
  s_add_u32 s14, s14, 8454144
  v_add_u32 v62, 4096, v4
  s_mov_b32 s53, 0
t4_poll:
  buffer_load_dwordx4 v[216:219], v4, s[20:23], s14 offen offset:0 sc1
  buffer_load_dwordx4 v[220:223], v4, s[20:23], s14 offen offset:512 sc1
  buffer_load_dwordx4 v[224:227], v4, s[20:23], s14 offen offset:1024 sc1
  buffer_load_dwordx4 v[228:231], v4, s[20:23], s14 offen offset:1536 sc1
  buffer_load_dwordx4 v[232:235], v4, s[20:23], s14 offen offset:2048 sc1
  buffer_load_dwordx4 v[236:239], v4, s[20:23], s14 offen offset:2560 sc1
  buffer_load_dwordx4 v[240:243], v4, s[20:23], s14 offen offset:3072 sc1
  buffer_load_dwordx4 v[244:247], v4, s[20:23], s14 offen offset:3584 sc1
  buffer_load_dwordx4 v[248:251], v62, s[20:23], s14 offen offset:0 sc1
  buffer_load_dwordx4 v[36:39], v62, s[20:23], s14 offen offset:512 sc1
  buffer_load_dwordx4 v[40:43], v62, s[20:23], s14 offen offset:1024 sc1
  buffer_load_dwordx4 v[44:47], v62, s[20:23], s14 offen offset:1536 sc1
  buffer_load_dwordx4 v[56:59], v62, s[20:23], s14 offen offset:2048 sc1
  buffer_load_dwordx4 v[64:67], v62, s[20:23], s14 offen offset:2560 sc1
  v_mov_b32 v3, 0
  s_waitcnt vmcnt(13)
  v_max3_u32 v3, v3, v216, v217
  v_max3_u32 v3, v3, v218, v219
  s_waitcnt vmcnt(12)
  v_max3_u32 v3, v3, v220, v221
  v_max3_u32 v3, v3, v222, v223
  s_waitcnt vmcnt(11)
  v_max3_u32 v3, v3, v224, v225
  v_max3_u32 v3, v3, v226, v227
  s_waitcnt vmcnt(10)
  v_max3_u32 v3, v3, v228, v229
  v_max3_u32 v3, v3, v230, v231
  s_waitcnt vmcnt(9)
  v_max3_u32 v3, v3, v232, v233
  v_max3_u32 v3, v3, v234, v235
  s_waitcnt vmcnt(8)
  v_max3_u32 v3, v3, v236, v237
  v_max3_u32 v3, v3, v238, v239
  s_waitcnt vmcnt(7)
  v_max3_u32 v3, v3, v240, v241
  v_max3_u32 v3, v3, v242, v243
  s_waitcnt vmcnt(6)
  v_max3_u32 v3, v3, v244, v245
  v_max3_u32 v3, v3, v246, v247
  s_waitcnt vmcnt(5)
  v_max3_u32 v3, v3, v248, v249
  v_max3_u32 v3, v3, v250, v251
  s_waitcnt vmcnt(4)
  v_max3_u32 v3, v3, v36, v37
  v_max3_u32 v3, v3, v38, v39
  s_waitcnt vmcnt(3)
  v_max3_u32 v3, v3, v40, v41
  v_max3_u32 v3, v3, v42, v43
  s_waitcnt vmcnt(2)
  v_max3_u32 v3, v3, v44, v45
  v_max3_u32 v3, v3, v46, v47
  s_waitcnt vmcnt(1)
  v_max3_u32 v3, v3, v56, v57
  v_max3_u32 v3, v3, v58, v59
  s_waitcnt vmcnt(0)
  v_max3_u32 v3, v3, v64, v65
  v_max3_u32 v3, v3, v66, v67
  v_cmp_eq_u32 s[54:55], -1, v3
  s_nop 3
  s_cmp_eq_u64 s[54:55], 0
  s_cbranch_scc1 t4_poll_ok
  s_add_u32 s53, s53, 1
  s_cmp_gt_u32 s53, 4194304
  s_cbranch_scc1 t4_poll_ok
  s_branch t4_poll
t4_poll_ok:
  s_waitcnt lgkmcnt(0)
  v_mfma_f32_16x16x32_bf16 v[8:11], v[216:219], v[72:75], v[8:11]
  v_mfma_f32_16x16x32_bf16 v[12:15], v[216:219], v[128:131], v[12:15]
  v_mfma_f32_16x16x32_bf16 v[8:11], v[220:223], v[76:79], v[8:11]
  v_mfma_f32_16x16x32_bf16 v[12:15], v[220:223], v[132:135], v[12:15]
  v_mfma_f32_16x16x32_bf16 v[8:11], v[224:227], v[80:83], v[8:11]
  v_mfma_f32_16x16x32_bf16 v[12:15], v[224:227], v[136:139], v[12:15]
  v_mfma_f32_16x16x32_bf16 v[8:11], v[228:231], v[84:87], v[8:11]
  v_mfma_f32_16x16x32_bf16 v[12:15], v[228:231], v[140:143], v[12:15]
  v_mfma_f32_16x16x32_bf16 v[8:11], v[232:235], v[88:91], v[8:11]
  v_mfma_f32_16x16x32_bf16 v[12:15], v[232:235], v[144:147], v[12:15]
  v_mfma_f32_16x16x32_bf16 v[8:11], v[236:239], v[92:95], v[8:11]
  v_mfma_f32_16x16x32_bf16 v[12:15], v[236:239], v[148:151], v[12:15]
  v_mfma_f32_16x16x32_bf16 v[8:11], v[240:243], v[96:99], v[8:11]
  v_mfma_f32_16x16x32_bf16 v[12:15], v[240:243], v[152:155], v[12:15]
  v_mfma_f32_16x16x32_bf16 v[8:11], v[244:247], v[100:103], v[8:11]
  v_mfma_f32_16x16x32_bf16 v[12:15], v[244:247], v[156:159], v[12:15]
  v_mfma_f32_16x16x32_bf16 v[8:11], v[248:251], v[104:107], v[8:11]
  v_mfma_f32_16x16x32_bf16 v[12:15], v[248:251], v[160:163], v[12:15]
  v_mfma_f32_16x16x32_bf16 v[8:11], v[36:39], v[108:111], v[8:11]
  v_mfma_f32_16x16x32_bf16 v[12:15], v[36:39], v[164:167], v[12:15]
  v_mfma_f32_16x16x32_bf16 v[8:11], v[40:43], v[112:115], v[8:11]
  v_mfma_f32_16x16x32_bf16 v[12:15], v[40:43], v[168:171], v[12:15]
  v_mfma_f32_16x16x32_bf16 v[8:11], v[44:47], v[116:119], v[8:11]
  v_mfma_f32_16x16x32_bf16 v[12:15], v[44:47], v[172:175], v[12:15]
  v_mfma_f32_16x16x32_bf16 v[8:11], v[56:59], v[120:123], v[8:11]
  v_mfma_f32_16x16x32_bf16 v[12:15], v[56:59], v[176:179], v[12:15]
  v_mfma_f32_16x16x32_bf16 v[8:11], v[64:67], v[124:127], v[8:11]
  v_mfma_f32_16x16x32_bf16 v[12:15], v[64:67], v[180:183], v[12:15]
  s_nop 15
  v_lshlrev_b32 v3, 4, v0
  s_lshl_b32 s33, s13, 11
  v_add_u32 v3, s33, v3
  ds_write_b128 v3, v[8:11] offset:256
  ds_write_b128 v3, v[12:15] offset:1280
  s_waitcnt lgkmcnt(0)
  s_barrier
  s_cmp_lg_u32 s13, 0
  s_cbranch_scc1 t4_done
  v_lshlrev_b32 v3, 4, v0
  ds_read_b128 v[72:75], v3 offset:2304
  ds_read_b128 v[76:79], v3 offset:3328
  ds_read_b128 v[80:83], v3 offset:4352
  ds_read_b128 v[84:87], v3 offset:5376
  ds_read_b128 v[88:91], v3 offset:6400
  ds_read_b128 v[92:95], v3 offset:7424
  v_cmp_gt_u32 vcc, 32, v0
  s_and_saveexec_b64 s[40:41], vcc
  s_waitcnt lgkmcnt(0)
  v_add_f32 v8, v8, v72
  v_add_f32 v60, v80, v88
  v_add_f32 v8, v8, v60
  v_cvt_pk_bf16_f32 v8, v8, v8
  v_lshlrev_b32 v8, 16, v8
  v_mul_f32 v8, v8, v24
  v_cvt_pk_bf16_f32 v8, v8, v8
  v_lshlrev_b32 v8, 16, v8
  v_add_f32 v61, v196, v8
  v_cvt_pk_bf16_f32 v61, v61, v61
  v_lshlrev_b32 v61, 16, v61
  v_add_f32 v61, v192, v61
  v_cvt_pk_bf16_f32 v61, v61, v61
  buffer_store_short v61, v28, s[48:51], 0 offen offset:0
  v_add_f32 v9, v9, v73
  v_add_f32 v60, v81, v89
  v_add_f32 v9, v9, v60
  v_cvt_pk_bf16_f32 v9, v9, v9
  v_lshlrev_b32 v9, 16, v9
  v_mul_f32 v9, v9, v25
  v_cvt_pk_bf16_f32 v9, v9, v9
  v_lshlrev_b32 v9, 16, v9
  v_add_f32 v61, v197, v9
  v_cvt_pk_bf16_f32 v61, v61, v61
  v_lshlrev_b32 v61, 16, v61
  v_add_f32 v61, v193, v61
  v_cvt_pk_bf16_f32 v61, v61, v61
  buffer_store_short v61, v29, s[48:51], 0 offen offset:0
  v_add_f32 v10, v10, v74
  v_add_f32 v60, v82, v90
  v_add_f32 v10, v10, v60
  v_cvt_pk_bf16_f32 v10, v10, v10
  v_lshlrev_b32 v10, 16, v10
  v_mul_f32 v10, v10, v26
  v_cvt_pk_bf16_f32 v10, v10, v10
  v_lshlrev_b32 v10, 16, v10
  v_add_f32 v61, v198, v10
  v_cvt_pk_bf16_f32 v61, v61, v61
  v_lshlrev_b32 v61, 16, v61
  v_add_f32 v61, v194, v61
  v_cvt_pk_bf16_f32 v61, v61, v61
  buffer_store_short v61, v30, s[48:51], 0 offen offset:0
  v_add_f32 v11, v11, v75
  v_add_f32 v60, v83, v91
  v_add_f32 v11, v11, v60
  v_cvt_pk_bf16_f32 v11, v11, v11
  v_lshlrev_b32 v11, 16, v11
  v_mul_f32 v11, v11, v27
  v_cvt_pk_bf16_f32 v11, v11, v11
  v_lshlrev_b32 v11, 16, v11
  v_add_f32 v61, v199, v11
  v_cvt_pk_bf16_f32 v61, v61, v61
  v_lshlrev_b32 v61, 16, v61
  v_add_f32 v61, v195, v61
  v_cvt_pk_bf16_f32 v61, v61, v61
  buffer_store_short v61, v31, s[48:51], 0 offen offset:0
  v_add_f32 v12, v12, v76
  v_add_f32 v60, v84, v92
  v_add_f32 v12, v12, v60
  v_cvt_pk_bf16_f32 v12, v12, v12
  v_lshlrev_b32 v12, 16, v12
  v_mul_f32 v12, v12, v24
  v_cvt_pk_bf16_f32 v12, v12, v12
  v_lshlrev_b32 v12, 16, v12
  v_add_f32 v61, v208, v12
  v_cvt_pk_bf16_f32 v61, v61, v61
  v_lshlrev_b32 v61, 16, v61
  v_add_f32 v61, v204, v61
  v_cvt_pk_bf16_f32 v61, v61, v61
  buffer_store_short v61, v28, s[48:51], 0 offen offset:32
  v_add_f32 v13, v13, v77
  v_add_f32 v60, v85, v93
  v_add_f32 v13, v13, v60
  v_cvt_pk_bf16_f32 v13, v13, v13
  v_lshlrev_b32 v13, 16, v13
  v_mul_f32 v13, v13, v25
  v_cvt_pk_bf16_f32 v13, v13, v13
  v_lshlrev_b32 v13, 16, v13
  v_add_f32 v61, v209, v13
  v_cvt_pk_bf16_f32 v61, v61, v61
  v_lshlrev_b32 v61, 16, v61
  v_add_f32 v61, v205, v61
  v_cvt_pk_bf16_f32 v61, v61, v61
  buffer_store_short v61, v29, s[48:51], 0 offen offset:32
  v_add_f32 v14, v14, v78
  v_add_f32 v60, v86, v94
  v_add_f32 v14, v14, v60
  v_cvt_pk_bf16_f32 v14, v14, v14
  v_lshlrev_b32 v14, 16, v14
  v_mul_f32 v14, v14, v26
  v_cvt_pk_bf16_f32 v14, v14, v14
  v_lshlrev_b32 v14, 16, v14
  v_add_f32 v61, v210, v14
  v_cvt_pk_bf16_f32 v61, v61, v61
  v_lshlrev_b32 v61, 16, v61
  v_add_f32 v61, v206, v61
  v_cvt_pk_bf16_f32 v61, v61, v61
  buffer_store_short v61, v30, s[48:51], 0 offen offset:32
  v_add_f32 v15, v15, v79
  v_add_f32 v60, v87, v95
  v_add_f32 v15, v15, v60
  v_cvt_pk_bf16_f32 v15, v15, v15
  v_lshlrev_b32 v15, 16, v15
  v_mul_f32 v15, v15, v27
  v_cvt_pk_bf16_f32 v15, v15, v15
  v_lshlrev_b32 v15, 16, v15
  v_add_f32 v61, v211, v15
  v_cvt_pk_bf16_f32 v61, v61, v61
  v_lshlrev_b32 v61, 16, v61
  v_add_f32 v61, v207, v61
  v_cvt_pk_bf16_f32 v61, v61, v61
  buffer_store_short v61, v31, s[48:51], 0 offen offset:32
t4_done:
  s_endpgm
.section .rodata,"a"
.p2align 6
.amdhsa_kernel f_kernel
  .amdhsa_next_free_vgpr 164
  .amdhsa_next_free_sgpr 102
  .amdhsa_accum_offset 164
  .amdhsa_group_segment_fixed_size 0
  .amdhsa_kernarg_size 104
  .amdhsa_user_sgpr_count 2
  .amdhsa_user_sgpr_kernarg_segment_ptr 1
  .amdhsa_system_sgpr_workgroup_id_x 1
.end_amdhsa_kernel
.p2align 6
.amdhsa_kernel t4_kernel
  .amdhsa_next_free_vgpr 252
  .amdhsa_next_free_sgpr 102
  .amdhsa_accum_offset 252
  .amdhsa_group_segment_fixed_size 0
  .amdhsa_kernarg_size 104
  .amdhsa_user_sgpr_count 2
  .amdhsa_user_sgpr_kernarg_segment_ptr 1
  .amdhsa_system_sgpr_workgroup_id_x 1
.end_amdhsa_kernel
```
